```python
import torch

def _softmax(x, axis=-1):
    return torch.softmax(x, dim=axis)
def _gelu(x):
    return torch.nn.functional.gelu(x, approximate="tanh")
def _silu(x):
    return torch.nn.functional.silu(x)
def _sigmoid(x):
    return torch.sigmoid(x)
def _layernorm(x, axis=-1, eps=1e-5):
    m = x.mean(dim=axis, keepdim=True)
    v = x.var(dim=axis, keepdim=True, unbiased=False)
    return (x - m) / torch.sqrt(v + eps)
def _scatter_add(tgt, idx, src, axis=0):
    return tgt.clone().index_add_(axis, idx, src)
def _segment_sum(src, seg, n):
    out = torch.zeros((n,) + src.shape[1:], dtype=src.dtype)
    return out.index_add_(0, seg, src)
def _pad(x, pw):
    flat = tuple(v for pair in reversed(pw) for v in pair)
    return torch.nn.functional.pad(x, flat)

kernel_name = 'gated_mix__ssm_conv_h3__glu_gated_swiglu__prompt'

def setup_inputs():

    _w = (lambda a: (lambda t: t.to(torch.bfloat16) if t.is_floating_point() else t)(torch.as_tensor(a)))
    def _A_setup():
        B, S, D = 1, 2048, 640
        ks = 4
        return {
            "q": _w((lambda *s: torch.randn(*s, dtype=torch.bfloat16) * 0.05)(B, S, D)),
            "k": _w((lambda *s: torch.randn(*s, dtype=torch.bfloat16) * 0.2)(B, S, D)),
            "v": _w((lambda *s: torch.randn(*s, dtype=torch.bfloat16) * 0.2)(B, S, D)),
            "shift_k": _w((lambda *s: torch.randn(*s, dtype=torch.bfloat16) * 0.2)(D, ks) * 0.5),
            "ssm_k": _w((lambda *s: torch.randn(*s, dtype=torch.bfloat16) * 0.2)(D, S) * (1.0 / S ** 0.5)),
            "ssm_D": _w((lambda *s: torch.randn(*s, dtype=torch.bfloat16) * 0.2)(D)),
        }
    _A_in = _A_setup()

    def _B_setup():
        B, S, D, F = 1, 2048, 640, 1728
        return {
            "x": _w((lambda *s: torch.randn(*s, dtype=torch.bfloat16) * 0.05)(B, S, D)),
            "w1": _w((lambda *s: torch.randn(*s, dtype=torch.bfloat16) * 0.4)(D, F) * (2.0 / D) ** 0.5),
            "w3": _w((lambda *s: torch.randn(*s, dtype=torch.bfloat16) * 0.4)(D, F) * (2.0 / D) ** 0.5),
            "w2": _w((lambda *s: torch.randn(*s, dtype=torch.bfloat16) * 0.4)(F, D) * (2.0 / F) ** 0.5),
        }
    _B_in = _B_setup()

    return {
        "A_q": _A_in["q"],
        "A_k": _A_in["k"],
        "A_v": _A_in["v"],
        "A_shift_k": _A_in["shift_k"],
        "A_ssm_k": _A_in["ssm_k"],
        "A_ssm_D": _A_in["ssm_D"],
        "B_x": _B_in["x"],
        "B_w1": _B_in["w1"],
        "B_w3": _B_in["w3"],
        "B_w2": _B_in["w2"],
        "gate_w": _w((lambda *s: torch.randn(*s, dtype=torch.bfloat16) * 0.05)(640) * 16.0),
    }

def reference(A_q, A_k, A_v, A_shift_k, A_ssm_k, A_ssm_D, B_x, B_w1, B_w3, B_w2, gate_w):
    def _A_ref(q, k, v, shift_k, ssm_k, ssm_D):
        B, S, D = q.shape
        ks = shift_k.shape[-1]
        k_pad = _pad(k, ((0, 0), (ks - 1, 0), (0, 0)))
        k_shift = torch.zeros_like(k)
        for t in range(ks):
            k_shift = k_shift + k_pad[:, t:t + S, :] * shift_k[:, ks - 1 - t][None, None, :]
        kv = k_shift * v
        L = 2 * S
        kv_pad = _pad(kv, ((0, 0), (0, S), (0, 0)))
        kf_pad = _pad(ssm_k, ((0, 0), (0, S)))
        kv_f = (lambda x, axes=(-2,-1): torch.fft.rfft2(x.float(), dim=axes))(kv_pad[:, None, :, :], axes=(1, 2))
        kf_f = (lambda x, axes=(-2,-1): torch.fft.rfft2(x.float(), dim=axes))(kf_pad[:, None, :], axes=(1, 2))
        kf_f = (lambda x, *d: x.permute(*d))(kf_f, 1, 2, 0)
        y_f = kv_f * kf_f[None, :, :, :]
        y = (lambda x, s, axes=(-2,-1): torch.fft.irfft2(x, s=s, dim=axes).to(torch.bfloat16))(y_f, (1, L), axes=(1, 2))[:, 0, :S, :]
        y = y + kv * ssm_D[None, None, :]
        return q * y

    def _B_ref(x, w1, w3, w2):
        gate = torch.einsum("bsd,df->bsf", x, w1)
        up = torch.einsum("bsd,df->bsf", x, w3)
        h = _silu(gate) * up
        out = torch.einsum("bsf,fd->bsd", h, w2)
        return out

    x = A_q
    g = _sigmoid((x * gate_w).sum(-1, keepdims=True))
    a = _A_ref(x, A_k, A_v, A_shift_k, A_ssm_k, A_ssm_D)
    b = _B_ref(x, B_w1, B_w3, B_w2)
    return g * a + (1 - g) * b
```

```asm
; @launch grid=(256,1,1) block=(512,1,1) lds=163840
.amdgcn_target "amdgcn-amd-amdhsa--gfx950"
.text
.globl gated_mix__ssm_conv_h3__glu_gated_swiglu__prompt_kernel
.type gated_mix__ssm_conv_h3__glu_gated_swiglu__prompt_kernel,@function
.p2align 8
gated_mix__ssm_conv_h3__glu_gated_swiglu__prompt_kernel:
K_code0:
    s_cmp_ge_u32 s2, 256
    s_cbranch_scc1 K_exit
    s_load_dwordx16 s[16:31], s[0:1], 0
    s_load_dwordx8 s[32:39], s[0:1], 64
    s_load_dwordx4 s[40:43], s[0:1], 96
    s_memrealtime s[74:75]
    v_lshrrev_b32 v1, 6, v0
    s_and_b32 s3, s2, 7
    v_readfirstlane_b32 s10, v1
    v_and_b32 v1, 63, v0
    s_lshr_b32 s4, s2, 3
    v_mov_b32 v252, 0
    v_mov_b32 v253, 1
    v_mov_b32 v238, 0
    v_mov_b32 v10, 0
    s_mov_b32 s5, 0x1000000
    v_mov_b32 v248, 0
    v_mov_b32 v254, 163808
    ds_write_b32 v254, v252
    ds_write_b32 v254, v252 offset:4
    ds_write_b32 v254, v252 offset:16
    ds_write_b32 v254, v252 offset:20
    ds_write_b32 v254, v252 offset:24
    v_lshlrev_b32 v237, 4, v1
    s_cmp_lt_u32 s10, 4
    s_cselect_b32 s11, 16, 0
    v_add_u32 v255, s11, v254
    s_cmp_ge_u32 s4, 27
    s_cbranch_scc1 K_prep
    s_and_b32 s9, s3, 3
    s_mul_i32 s9, s9, 27
    s_add_u32 s9, s9, s4
    s_and_b32 s8, s3, 4
    s_and_b32 s11, s9, 3
    s_add_u32 s8, s8, s11
    s_lshr_b32 s9, s9, 2
    s_cmp_lt_u32 s10, 4
    s_cbranch_scc0 K_comp
    v_lshrrev_b32 v13, 3, v1
    v_and_b32 v15, 7, v1
    s_lshl_b32 s11, s10, 3
    v_add_u32 v16, s11, v13
    v_bfe_u32 v14, v16, 1, 3
    v_xor_b32 v14, v14, v15
    v_lshlrev_b32 v14, 4, v14
    v_mul_u32_u24 v2, 1280, v16
    v_add_u32 v2, v2, v14
    v_mov_b32 v3, v2
    s_cmp_lg_u32 s10, 2
    s_cbranch_scc1 LP_1
    v_and_b32 v14, 2, v13
    v_xor_b32 v14, v14, v15
    v_lshlrev_b32 v14, 4, v14
    v_mul_u32_u24 v2, 3456, v13
    v_xor_b32 v16, 64, v14
    v_add_u32 v3, v2, v16
    v_add_u32 v2, v2, v14
LP_1:
    s_mul_i32 s11, s8, 3
    s_add_u32 s11, s11, s9
    s_mul_i32 s69, s11, 205
    s_lshr_b32 s69, s69, 11
    s_mul_i32 s69, s69, 10
    s_sub_u32 s68, s11, s69
    s_mul_i32 s65, s8, 327680
    s_lshl_b32 s66, s9, 7
    s_sub_u32 s67, 0x21c000, s66
    s_lshl_b32 s62, s10, 10
    s_cmp_eq_u32 s10, 2
    s_cselect_b32 s62, 0x8000, s62
    s_lshr_b32 s11, s4, 2
    s_mul_i32 s11, s11, 43
    v_add_u32 v48, s11, v1
    v_min_u32 v48, 255, v48
    v_mul_u32_u24 v48, 1280, v48
    s_and_b32 s11, s8, 3
    s_lshl_b32 s11, s11, 4
    v_add_u32 v49, s11, v1
    v_mul_u32_u24 v49, 3456, v49
    s_waitcnt lgkmcnt(0)
    s_or_b32 s11, s2, s10
    s_cmp_lg_u32 s11, 0
    s_cbranch_scc1 NP_2
    s_or_b32 s74, s74, 1
    v_mov_b32 v250, s74
    v_mov_b32 v251, s75
    v_lshlrev_b32 v249, 7, v1
    s_mov_b64 exec, 3
    global_store_dwordx2 v249, v[250:251], s[40:41] sc1
    s_mov_b64 exec, -1
NP_2:
    s_mov_b32 s28, s68
    s_add_u32 s48, s30, s66
    s_addc_u32 s49, s31, 0
    s_mov_b32 s50, s67
    s_mov_b32 s51, 0x00020000
    s_add_u32 s52, s32, s66
    s_addc_u32 s53, s33, 0
    s_mov_b32 s54, s67
    s_mov_b32 s55, 0x00020000
    s_add_u32 s44, s16, s65
    s_addc_u32 s45, s17, 0
    s_mov_b32 s46, 0x50000
    s_mov_b32 s47, 0x00020000
    s_cmp_eq_u32 s10, 3
    s_cbranch_scc1 K_svc
    s_cmp_eq_u32 s10, 2
    s_cselect_b32 s48, s48, s44
    s_cselect_b32 s52, s52, s44
    s_cselect_b32 s49, s49, s45
    s_cselect_b32 s53, s53, s45
    s_cselect_b32 s50, s50, s46
    s_cselect_b32 s54, s54, s46
    s_movk_i32 s24, 2048
    s_cmov_b32 s24, 1024
    s_movk_i32 s25, 20480
    s_cmov_b32 s25, 27648
    s_movk_i32 s26, 20480
    s_cmov_b32 s26, -193536
    s_movk_i32 s27, 128
    s_cmov_b32 s27, 221184
    s_add_u32 s29, s28, 0
    s_sub_u32 s61, s29, 10
    s_min_u32 s29, s29, s61
    s_mul_i32 s60, s29, s27
    s_add_u32 m0, s62, 0x0
    s_nop 0
    buffer_load_dwordx4 v2, s[48:51], s60 offen lds
    s_add_u32 m0, m0, s24
    s_add_u32 s60, s60, s25
    buffer_load_dwordx4 v3, s[48:51], s60 offen lds
    s_add_u32 m0, m0, s24
    s_add_u32 s60, s60, s25
    buffer_load_dwordx4 v2, s[48:51], s60 offen lds
    s_add_u32 m0, m0, s24
    s_add_u32 s60, s60, s25
    buffer_load_dwordx4 v3, s[48:51], s60 offen lds
    s_add_u32 m0, m0, s24
    s_add_u32 s60, s60, s25
    buffer_load_dwordx4 v2, s[48:51], s60 offen lds
    s_add_u32 m0, m0, s24
    s_add_u32 s60, s60, s25
    buffer_load_dwordx4 v3, s[48:51], s60 offen lds
    s_add_u32 m0, m0, s24
    s_add_u32 s60, s60, s25
    buffer_load_dwordx4 v2, s[48:51], s60 offen lds
    s_add_u32 m0, m0, s24
    s_add_u32 s60, s60, s25
    buffer_load_dwordx4 v3, s[48:51], s60 offen lds
    s_add_u32 m0, m0, s24
    s_add_u32 s60, s60, s26
    buffer_load_dwordx4 v2, s[52:55], s60 offen lds
    s_add_u32 m0, m0, s24
    s_add_u32 s60, s60, s25
    buffer_load_dwordx4 v3, s[52:55], s60 offen lds
    s_add_u32 m0, m0, s24
    s_add_u32 s60, s60, s25
    buffer_load_dwordx4 v2, s[52:55], s60 offen lds
    s_add_u32 m0, m0, s24
    s_add_u32 s60, s60, s25
    buffer_load_dwordx4 v3, s[52:55], s60 offen lds
    s_add_u32 m0, m0, s24
    s_add_u32 s60, s60, s25
    buffer_load_dwordx4 v2, s[52:55], s60 offen lds
    s_add_u32 m0, m0, s24
    s_add_u32 s60, s60, s25
    buffer_load_dwordx4 v3, s[52:55], s60 offen lds
    s_add_u32 m0, m0, s24
    s_add_u32 s60, s60, s25
    buffer_load_dwordx4 v2, s[52:55], s60 offen lds
    s_add_u32 m0, m0, s24
    s_add_u32 s60, s60, s25
    buffer_load_dwordx4 v3, s[52:55], s60 offen lds
    s_add_u32 s29, s28, 1
    s_sub_u32 s61, s29, 10
    s_min_u32 s29, s29, s61
    s_mul_i32 s60, s29, s27
    s_add_u32 m0, s62, 0x18000
    s_nop 0
    buffer_load_dwordx4 v2, s[48:51], s60 offen lds
    s_add_u32 m0, m0, s24
    s_add_u32 s60, s60, s25
    buffer_load_dwordx4 v3, s[48:51], s60 offen lds
    s_add_u32 m0, m0, s24
    s_add_u32 s60, s60, s25
    buffer_load_dwordx4 v2, s[48:51], s60 offen lds
    s_add_u32 m0, m0, s24
    s_add_u32 s60, s60, s25
    buffer_load_dwordx4 v3, s[48:51], s60 offen lds
    s_add_u32 m0, m0, s24
    s_add_u32 s60, s60, s25
    buffer_load_dwordx4 v2, s[48:51], s60 offen lds
    s_add_u32 m0, m0, s24
    s_add_u32 s60, s60, s25
    buffer_load_dwordx4 v3, s[48:51], s60 offen lds
    s_add_u32 m0, m0, s24
    s_add_u32 s60, s60, s25
    buffer_load_dwordx4 v2, s[48:51], s60 offen lds
    s_add_u32 m0, m0, s24
    s_add_u32 s60, s60, s25
    buffer_load_dwordx4 v3, s[48:51], s60 offen lds
    s_add_u32 m0, m0, s24
    s_add_u32 s60, s60, s26
    buffer_load_dwordx4 v2, s[52:55], s60 offen lds
    s_add_u32 m0, m0, s24
    s_add_u32 s60, s60, s25
    buffer_load_dwordx4 v3, s[52:55], s60 offen lds
    s_add_u32 m0, m0, s24
    s_add_u32 s60, s60, s25
    buffer_load_dwordx4 v2, s[52:55], s60 offen lds
    s_add_u32 m0, m0, s24
    s_add_u32 s60, s60, s25
    buffer_load_dwordx4 v3, s[52:55], s60 offen lds
    s_add_u32 m0, m0, s24
    s_add_u32 s60, s60, s25
    buffer_load_dwordx4 v2, s[52:55], s60 offen lds
    s_add_u32 m0, m0, s24
    s_add_u32 s60, s60, s25
    buffer_load_dwordx4 v3, s[52:55], s60 offen lds
    s_add_u32 m0, m0, s24
    s_add_u32 s60, s60, s25
    buffer_load_dwordx4 v2, s[52:55], s60 offen lds
    s_add_u32 m0, m0, s24
    s_add_u32 s60, s60, s25
    buffer_load_dwordx4 v3, s[52:55], s60 offen lds
    s_add_u32 s12, s42, 0x1500000
    s_addc_u32 s13, s43, 0
    s_mov_b32 s14, 0xa0000
    s_mov_b32 s15, 0x00020000
    s_lshl_b32 s65, s9, 2
    s_add_u32 s65, s65, s10
    s_and_b32 s65, s65, 31
    s_lshl_b32 s11, s65, 10
    v_add_u32 v4, s11, v237
    v_add_u32 v5, 0x18000, v4
    s_and_b32 s11, s10, 1
    s_lshl_b32 s11, s11, 2
    v_lshrrev_b32 v12, 4, v1
    v_add_u32 v12, s11, v12
    v_and_b32 v13, 7, v1
    v_xor_b32 v12, v12, v13
    s_lshl_b32 s11, s28, 7
    s_add_u32 s11, s11, 159744
    v_lshl_add_u32 v6, v12, 4, s11
    v_mov_b32 v7, 0
    s_lshl_b32 s64, s8, 5
    s_add_u32 s64, s64, s65
    s_lshr_b32 s5, s64, 3
    s_lshl_b32 s5, s5, 6
    s_and_b32 s11, s65, 7
    s_add_u32 s5, s5, s11
    s_add_u32 s5, s5, 54
    s_lshl_b32 s5, s5, 7
    s_lshl_b32 s64, s64, 5
    s_cmp_lt_u32 s9, 8
    s_cselect_b32 s64, s64, 0x1000000
    s_cselect_b32 s5, s5, 0x1000000
    s_mul_i32 s70, s8, 27
    s_add_u32 s70, s70, s9
    s_waitcnt vmcnt(16)
    s_barrier
    s_setprio 2
    s_add_u32 s29, s28, 2
    s_sub_u32 s61, s29, 10
    s_min_u32 s29, s29, s61
    s_mul_i32 s60, s29, s27
    s_add_u32 m0, s62, 0xc000
    s_nop 0
    buffer_load_dwordx4 v2, s[48:51], s60 offen lds
    s_add_u32 m0, m0, s24
    s_add_u32 s60, s60, s25
    buffer_load_dwordx4 v3, s[48:51], s60 offen lds
    s_add_u32 m0, m0, s24
    s_add_u32 s60, s60, s25
    buffer_load_dwordx4 v2, s[48:51], s60 offen lds
    s_add_u32 m0, m0, s24
    s_add_u32 s60, s60, s25
    buffer_load_dwordx4 v3, s[48:51], s60 offen lds
    s_add_u32 m0, m0, s24
    s_add_u32 s60, s60, s25
    buffer_load_dwordx4 v2, s[48:51], s60 offen lds
    s_add_u32 m0, m0, s24
    s_add_u32 s60, s60, s25
    buffer_load_dwordx4 v3, s[48:51], s60 offen lds
    s_add_u32 m0, m0, s24
    s_add_u32 s60, s60, s25
    buffer_load_dwordx4 v2, s[48:51], s60 offen lds
    s_add_u32 m0, m0, s24
    s_add_u32 s60, s60, s25
    buffer_load_dwordx4 v3, s[48:51], s60 offen lds
    s_add_u32 m0, m0, s24
    s_add_u32 s60, s60, s26
    buffer_load_dwordx4 v2, s[52:55], s60 offen lds
    s_add_u32 m0, m0, s24
    s_add_u32 s60, s60, s25
    buffer_load_dwordx4 v3, s[52:55], s60 offen lds
    s_add_u32 m0, m0, s24
    s_add_u32 s60, s60, s25
    buffer_load_dwordx4 v2, s[52:55], s60 offen lds
    s_add_u32 m0, m0, s24
    s_add_u32 s60, s60, s25
    buffer_load_dwordx4 v3, s[52:55], s60 offen lds
    s_add_u32 m0, m0, s24
    s_add_u32 s60, s60, s25
    buffer_load_dwordx4 v2, s[52:55], s60 offen lds
    s_add_u32 m0, m0, s24
    s_add_u32 s60, s60, s25
    buffer_load_dwordx4 v3, s[52:55], s60 offen lds
    s_add_u32 m0, m0, s24
    s_add_u32 s60, s60, s25
    buffer_load_dwordx4 v2, s[52:55], s60 offen lds
    s_add_u32 m0, m0, s24
    s_add_u32 s60, s60, s25
    buffer_load_dwordx4 v3, s[52:55], s60 offen lds
    ds_read_b128 v[12:15], v4 offset:0
    ds_read_b128 v[16:19], v6 offset:0
    s_waitcnt lgkmcnt(0)
    v_lshlrev_b32 v100, 16, v12
    v_lshlrev_b32 v101, 16, v16
    v_and_b32 v102, 0xffff0000, v12
    v_and_b32 v103, 0xffff0000, v16
    v_fmac_f32 v7, v100, v101
    v_fmac_f32 v7, v102, v103
    v_lshlrev_b32 v100, 16, v13
    v_lshlrev_b32 v101, 16, v17
    v_and_b32 v102, 0xffff0000, v13
    v_and_b32 v103, 0xffff0000, v17
    v_fmac_f32 v7, v100, v101
    v_fmac_f32 v7, v102, v103
    v_lshlrev_b32 v100, 16, v14
    v_lshlrev_b32 v101, 16, v18
    v_and_b32 v102, 0xffff0000, v14
    v_and_b32 v103, 0xffff0000, v18
    v_fmac_f32 v7, v100, v101
    v_fmac_f32 v7, v102, v103
    v_lshlrev_b32 v100, 16, v15
    v_lshlrev_b32 v101, 16, v19
    v_and_b32 v102, 0xffff0000, v15
    v_and_b32 v103, 0xffff0000, v19
    v_fmac_f32 v7, v100, v101
    v_fmac_f32 v7, v102, v103
    s_waitcnt vmcnt(16)
    s_barrier
    s_add_u32 s29, s28, 3
    s_sub_u32 s61, s29, 10
    s_min_u32 s29, s29, s61
    s_mul_i32 s60, s29, s27
    s_add_u32 m0, s62, 0x0
    s_nop 0
    buffer_load_dwordx4 v2, s[48:51], s60 offen lds
    s_add_u32 m0, m0, s24
    s_add_u32 s60, s60, s25
    buffer_load_dwordx4 v3, s[48:51], s60 offen lds
    s_add_u32 m0, m0, s24
    s_add_u32 s60, s60, s25
    buffer_load_dwordx4 v2, s[48:51], s60 offen lds
    s_add_u32 m0, m0, s24
    s_add_u32 s60, s60, s25
    buffer_load_dwordx4 v3, s[48:51], s60 offen lds
    s_add_u32 m0, m0, s24
    s_add_u32 s60, s60, s25
    buffer_load_dwordx4 v2, s[48:51], s60 offen lds
    s_add_u32 m0, m0, s24
    s_add_u32 s60, s60, s25
    buffer_load_dwordx4 v3, s[48:51], s60 offen lds
    s_add_u32 m0, m0, s24
    s_add_u32 s60, s60, s25
    buffer_load_dwordx4 v2, s[48:51], s60 offen lds
    s_add_u32 m0, m0, s24
    s_add_u32 s60, s60, s25
    buffer_load_dwordx4 v3, s[48:51], s60 offen lds
    s_add_u32 m0, m0, s24
    s_add_u32 s60, s60, s26
    buffer_load_dwordx4 v2, s[52:55], s60 offen lds
    s_add_u32 m0, m0, s24
    s_add_u32 s60, s60, s25
    buffer_load_dwordx4 v3, s[52:55], s60 offen lds
    s_add_u32 m0, m0, s24
    s_add_u32 s60, s60, s25
    buffer_load_dwordx4 v2, s[52:55], s60 offen lds
    s_add_u32 m0, m0, s24
    s_add_u32 s60, s60, s25
    buffer_load_dwordx4 v3, s[52:55], s60 offen lds
    s_add_u32 m0, m0, s24
    s_add_u32 s60, s60, s25
    buffer_load_dwordx4 v2, s[52:55], s60 offen lds
    s_add_u32 m0, m0, s24
    s_add_u32 s60, s60, s25
    buffer_load_dwordx4 v3, s[52:55], s60 offen lds
    s_add_u32 m0, m0, s24
    s_add_u32 s60, s60, s25
    buffer_load_dwordx4 v2, s[52:55], s60 offen lds
    s_add_u32 m0, m0, s24
    s_add_u32 s60, s60, s25
    buffer_load_dwordx4 v3, s[52:55], s60 offen lds
    ds_read_b128 v[12:15], v5 offset:0
    ds_read_b128 v[16:19], v6 offset:128
    s_waitcnt lgkmcnt(0)
    v_lshlrev_b32 v100, 16, v12
    v_lshlrev_b32 v101, 16, v16
    v_and_b32 v102, 0xffff0000, v12
    v_and_b32 v103, 0xffff0000, v16
    v_fmac_f32 v7, v100, v101
    v_fmac_f32 v7, v102, v103
    v_lshlrev_b32 v100, 16, v13
    v_lshlrev_b32 v101, 16, v17
    v_and_b32 v102, 0xffff0000, v13
    v_and_b32 v103, 0xffff0000, v17
    v_fmac_f32 v7, v100, v101
    v_fmac_f32 v7, v102, v103
    v_lshlrev_b32 v100, 16, v14
    v_lshlrev_b32 v101, 16, v18
    v_and_b32 v102, 0xffff0000, v14
    v_and_b32 v103, 0xffff0000, v18
    v_fmac_f32 v7, v100, v101
    v_fmac_f32 v7, v102, v103
    v_lshlrev_b32 v100, 16, v15
    v_lshlrev_b32 v101, 16, v19
    v_and_b32 v102, 0xffff0000, v15
    v_and_b32 v103, 0xffff0000, v19
    v_fmac_f32 v7, v100, v101
    v_fmac_f32 v7, v102, v103
    s_waitcnt vmcnt(16)
    s_barrier
    s_add_u32 s29, s28, 4
    s_sub_u32 s61, s29, 10
    s_min_u32 s29, s29, s61
    s_mul_i32 s60, s29, s27
    s_add_u32 m0, s62, 0x18000
    s_nop 0
    buffer_load_dwordx4 v2, s[48:51], s60 offen lds
    s_add_u32 m0, m0, s24
    s_add_u32 s60, s60, s25
    buffer_load_dwordx4 v3, s[48:51], s60 offen lds
    s_add_u32 m0, m0, s24
    s_add_u32 s60, s60, s25
    buffer_load_dwordx4 v2, s[48:51], s60 offen lds
    s_add_u32 m0, m0, s24
    s_add_u32 s60, s60, s25
    buffer_load_dwordx4 v3, s[48:51], s60 offen lds
    s_add_u32 m0, m0, s24
    s_add_u32 s60, s60, s25
    buffer_load_dwordx4 v2, s[48:51], s60 offen lds
    s_add_u32 m0, m0, s24
    s_add_u32 s60, s60, s25
    buffer_load_dwordx4 v3, s[48:51], s60 offen lds
    s_add_u32 m0, m0, s24
    s_add_u32 s60, s60, s25
    buffer_load_dwordx4 v2, s[48:51], s60 offen lds
    s_add_u32 m0, m0, s24
    s_add_u32 s60, s60, s25
    buffer_load_dwordx4 v3, s[48:51], s60 offen lds
    s_add_u32 m0, m0, s24
    s_add_u32 s60, s60, s26
    buffer_load_dwordx4 v2, s[52:55], s60 offen lds
    s_add_u32 m0, m0, s24
    s_add_u32 s60, s60, s25
    buffer_load_dwordx4 v3, s[52:55], s60 offen lds
    s_add_u32 m0, m0, s24
    s_add_u32 s60, s60, s25
    buffer_load_dwordx4 v2, s[52:55], s60 offen lds
    s_add_u32 m0, m0, s24
    s_add_u32 s60, s60, s25
    buffer_load_dwordx4 v3, s[52:55], s60 offen lds
    s_add_u32 m0, m0, s24
    s_add_u32 s60, s60, s25
    buffer_load_dwordx4 v2, s[52:55], s60 offen lds
    s_add_u32 m0, m0, s24
    s_add_u32 s60, s60, s25
    buffer_load_dwordx4 v3, s[52:55], s60 offen lds
    s_add_u32 m0, m0, s24
    s_add_u32 s60, s60, s25
    buffer_load_dwordx4 v2, s[52:55], s60 offen lds
    s_add_u32 m0, m0, s24
    s_add_u32 s60, s60, s25
    buffer_load_dwordx4 v3, s[52:55], s60 offen lds
    ds_read_b128 v[12:15], v4 offset:49152
    ds_read_b128 v[16:19], v6 offset:256
    ds_read_b64 v[250:251], v254 offset:8
    s_waitcnt lgkmcnt(1)
    v_lshlrev_b32 v100, 16, v12
    v_lshlrev_b32 v101, 16, v16
    v_and_b32 v102, 0xffff0000, v12
    v_and_b32 v103, 0xffff0000, v16
    v_fmac_f32 v7, v100, v101
    v_fmac_f32 v7, v102, v103
    v_lshlrev_b32 v100, 16, v13
    v_lshlrev_b32 v101, 16, v17
    v_and_b32 v102, 0xffff0000, v13
    v_and_b32 v103, 0xffff0000, v17
    v_fmac_f32 v7, v100, v101
    v_fmac_f32 v7, v102, v103
    v_lshlrev_b32 v100, 16, v14
    v_lshlrev_b32 v101, 16, v18
    v_and_b32 v102, 0xffff0000, v14
    v_and_b32 v103, 0xffff0000, v18
    v_fmac_f32 v7, v100, v101
    v_fmac_f32 v7, v102, v103
    v_lshlrev_b32 v100, 16, v15
    v_lshlrev_b32 v101, 16, v19
    v_and_b32 v102, 0xffff0000, v15
    v_and_b32 v103, 0xffff0000, v19
    v_fmac_f32 v7, v100, v101
    v_fmac_f32 v7, v102, v103
    s_waitcnt vmcnt(16) lgkmcnt(0)
    s_barrier
    s_add_u32 s29, s28, 5
    s_sub_u32 s61, s29, 10
    s_min_u32 s29, s29, s61
    s_mul_i32 s60, s29, s27
    s_add_u32 m0, s62, 0xc000
    s_nop 0
    buffer_load_dwordx4 v2, s[48:51], s60 offen lds
    s_add_u32 m0, m0, s24
    s_add_u32 s60, s60, s25
    buffer_load_dwordx4 v3, s[48:51], s60 offen lds
    s_add_u32 m0, m0, s24
    s_add_u32 s60, s60, s25
    buffer_load_dwordx4 v2, s[48:51], s60 offen lds
    s_add_u32 m0, m0, s24
    s_add_u32 s60, s60, s25
    buffer_load_dwordx4 v3, s[48:51], s60 offen lds
    s_add_u32 m0, m0, s24
    s_add_u32 s60, s60, s25
    buffer_load_dwordx4 v2, s[48:51], s60 offen lds
    s_add_u32 m0, m0, s24
    s_add_u32 s60, s60, s25
    buffer_load_dwordx4 v3, s[48:51], s60 offen lds
    s_add_u32 m0, m0, s24
    s_add_u32 s60, s60, s25
    buffer_load_dwordx4 v2, s[48:51], s60 offen lds
    s_add_u32 m0, m0, s24
    s_add_u32 s60, s60, s25
    buffer_load_dwordx4 v3, s[48:51], s60 offen lds
    s_add_u32 m0, m0, s24
    s_add_u32 s60, s60, s26
    buffer_load_dwordx4 v2, s[52:55], s60 offen lds
    s_add_u32 m0, m0, s24
    s_add_u32 s60, s60, s25
    buffer_load_dwordx4 v3, s[52:55], s60 offen lds
    s_add_u32 m0, m0, s24
    s_add_u32 s60, s60, s25
    buffer_load_dwordx4 v2, s[52:55], s60 offen lds
    s_add_u32 m0, m0, s24
    s_add_u32 s60, s60, s25
    buffer_load_dwordx4 v3, s[52:55], s60 offen lds
    s_add_u32 m0, m0, s24
    s_add_u32 s60, s60, s25
    buffer_load_dwordx4 v2, s[52:55], s60 offen lds
    s_add_u32 m0, m0, s24
    s_add_u32 s60, s60, s25
    buffer_load_dwordx4 v3, s[52:55], s60 offen lds
    s_add_u32 m0, m0, s24
    s_add_u32 s60, s60, s25
    buffer_load_dwordx4 v2, s[52:55], s60 offen lds
    s_add_u32 m0, m0, s24
    s_add_u32 s60, s60, s25
    buffer_load_dwordx4 v3, s[52:55], s60 offen lds
    ds_read_b128 v[12:15], v4 offset:0
    ds_read_b128 v[16:19], v6 offset:384
    v_readfirstlane_b32 s0, v250
    v_readfirstlane_b32 s1, v251
    s_lshl_b32 s8, s3, 2
    s_lshr_b32 s9, s4, 3
    s_add_u32 s8, s8, s9
    s_and_b32 s9, s4, 7
    s_mul_i32 s67, s9, 5120
    s_add_u32 s67, s67, 0x800000
    s_add_u32 s72, s42, s67
    s_addc_u32 s73, s43, 0
    s_mov_b32 s74, 0x213400
    s_mov_b32 s75, 0x00020000
    s_mov_b32 s65, s10
    s_and_b32 s7, s8, 3
    s_lshl_b32 s7, s7, 2
    s_mul_i32 s69, s10, 5120
    v_add_u32 v238, 4096, v237
    s_mul_i32 s67, s9, 5
    s_lshr_b32 s67, s67, 2
    s_mul_i32 s67, s67, 2304
    s_add_u32 s67, s67, 0x50000
    v_min_u32 v248, 35, v1
    v_lshl_add_u32 v248, v248, 7, s67
    s_waitcnt lgkmcnt(0)
    v_lshlrev_b32 v100, 16, v12
    v_lshlrev_b32 v101, 16, v16
    v_and_b32 v102, 0xffff0000, v12
    v_and_b32 v103, 0xffff0000, v16
    v_fmac_f32 v7, v100, v101
    v_fmac_f32 v7, v102, v103
    v_lshlrev_b32 v100, 16, v13
    v_lshlrev_b32 v101, 16, v17
    v_and_b32 v102, 0xffff0000, v13
    v_and_b32 v103, 0xffff0000, v17
    v_fmac_f32 v7, v100, v101
    v_fmac_f32 v7, v102, v103
    v_lshlrev_b32 v100, 16, v14
    v_lshlrev_b32 v101, 16, v18
    v_and_b32 v102, 0xffff0000, v14
    v_and_b32 v103, 0xffff0000, v18
    v_fmac_f32 v7, v100, v101
    v_fmac_f32 v7, v102, v103
    v_lshlrev_b32 v100, 16, v15
    v_lshlrev_b32 v101, 16, v19
    v_and_b32 v102, 0xffff0000, v15
    v_and_b32 v103, 0xffff0000, v19
    v_fmac_f32 v7, v100, v101
    v_fmac_f32 v7, v102, v103
    s_waitcnt vmcnt(16)
    s_barrier
    s_add_u32 s29, s28, 6
    s_sub_u32 s61, s29, 10
    s_min_u32 s29, s29, s61
    s_mul_i32 s60, s29, s27
    s_add_u32 m0, s62, 0x0
    s_nop 0
    buffer_load_dwordx4 v2, s[48:51], s60 offen lds
    s_add_u32 m0, m0, s24
    s_add_u32 s60, s60, s25
    buffer_load_dwordx4 v3, s[48:51], s60 offen lds
    s_add_u32 m0, m0, s24
    s_add_u32 s60, s60, s25
    buffer_load_dwordx4 v2, s[48:51], s60 offen lds
    s_add_u32 m0, m0, s24
    s_add_u32 s60, s60, s25
    buffer_load_dwordx4 v3, s[48:51], s60 offen lds
    s_add_u32 m0, m0, s24
    s_add_u32 s60, s60, s25
    buffer_load_dwordx4 v2, s[48:51], s60 offen lds
    s_add_u32 m0, m0, s24
    s_add_u32 s60, s60, s25
    buffer_load_dwordx4 v3, s[48:51], s60 offen lds
    s_add_u32 m0, m0, s24
    s_add_u32 s60, s60, s25
    buffer_load_dwordx4 v2, s[48:51], s60 offen lds
    s_add_u32 m0, m0, s24
    s_add_u32 s60, s60, s25
    buffer_load_dwordx4 v3, s[48:51], s60 offen lds
    s_add_u32 m0, m0, s24
    s_add_u32 s60, s60, s26
    buffer_load_dwordx4 v2, s[52:55], s60 offen lds
    s_add_u32 m0, m0, s24
    s_add_u32 s60, s60, s25
    buffer_load_dwordx4 v3, s[52:55], s60 offen lds
    s_add_u32 m0, m0, s24
    s_add_u32 s60, s60, s25
    buffer_load_dwordx4 v2, s[52:55], s60 offen lds
    s_add_u32 m0, m0, s24
    s_add_u32 s60, s60, s25
    buffer_load_dwordx4 v3, s[52:55], s60 offen lds
    s_add_u32 m0, m0, s24
    s_add_u32 s60, s60, s25
    buffer_load_dwordx4 v2, s[52:55], s60 offen lds
    s_add_u32 m0, m0, s24
    s_add_u32 s60, s60, s25
    buffer_load_dwordx4 v3, s[52:55], s60 offen lds
    s_add_u32 m0, m0, s24
    s_add_u32 s60, s60, s25
    buffer_load_dwordx4 v2, s[52:55], s60 offen lds
    s_add_u32 m0, m0, s24
    s_add_u32 s60, s60, s25
    buffer_load_dwordx4 v3, s[52:55], s60 offen lds
    ds_read_b128 v[12:15], v5 offset:0
    ds_read_b128 v[16:19], v6 offset:512
    s_waitcnt lgkmcnt(0)
    v_lshlrev_b32 v100, 16, v12
    v_lshlrev_b32 v101, 16, v16
    v_and_b32 v102, 0xffff0000, v12
    v_and_b32 v103, 0xffff0000, v16
    v_fmac_f32 v7, v100, v101
    v_fmac_f32 v7, v102, v103
    v_lshlrev_b32 v100, 16, v13
    v_lshlrev_b32 v101, 16, v17
    v_and_b32 v102, 0xffff0000, v13
    v_and_b32 v103, 0xffff0000, v17
    v_fmac_f32 v7, v100, v101
    v_fmac_f32 v7, v102, v103
    v_lshlrev_b32 v100, 16, v14
    v_lshlrev_b32 v101, 16, v18
    v_and_b32 v102, 0xffff0000, v14
    v_and_b32 v103, 0xffff0000, v18
    v_fmac_f32 v7, v100, v101
    v_fmac_f32 v7, v102, v103
    v_lshlrev_b32 v100, 16, v15
    v_lshlrev_b32 v101, 16, v19
    v_and_b32 v102, 0xffff0000, v15
    v_and_b32 v103, 0xffff0000, v19
    v_fmac_f32 v7, v100, v101
    v_fmac_f32 v7, v102, v103
    s_waitcnt vmcnt(16)
    s_barrier
    s_add_u32 s29, s28, 7
    s_sub_u32 s61, s29, 10
    s_min_u32 s29, s29, s61
    s_mul_i32 s60, s29, s27
    s_add_u32 m0, s62, 0x18000
    s_nop 0
    buffer_load_dwordx4 v2, s[48:51], s60 offen lds
    s_add_u32 m0, m0, s24
    s_add_u32 s60, s60, s25
    buffer_load_dwordx4 v3, s[48:51], s60 offen lds
    s_add_u32 m0, m0, s24
    s_add_u32 s60, s60, s25
    buffer_load_dwordx4 v2, s[48:51], s60 offen lds
    s_add_u32 m0, m0, s24
    s_add_u32 s60, s60, s25
    buffer_load_dwordx4 v3, s[48:51], s60 offen lds
    s_add_u32 m0, m0, s24
    s_add_u32 s60, s60, s25
    buffer_load_dwordx4 v2, s[48:51], s60 offen lds
    s_add_u32 m0, m0, s24
    s_add_u32 s60, s60, s25
    buffer_load_dwordx4 v3, s[48:51], s60 offen lds
    s_add_u32 m0, m0, s24
    s_add_u32 s60, s60, s25
    buffer_load_dwordx4 v2, s[48:51], s60 offen lds
    s_add_u32 m0, m0, s24
    s_add_u32 s60, s60, s25
    buffer_load_dwordx4 v3, s[48:51], s60 offen lds
    s_add_u32 m0, m0, s24
    s_add_u32 s60, s60, s26
    buffer_load_dwordx4 v2, s[52:55], s60 offen lds
    s_add_u32 m0, m0, s24
    s_add_u32 s60, s60, s25
    buffer_load_dwordx4 v3, s[52:55], s60 offen lds
    s_add_u32 m0, m0, s24
    s_add_u32 s60, s60, s25
    buffer_load_dwordx4 v2, s[52:55], s60 offen lds
    s_add_u32 m0, m0, s24
    s_add_u32 s60, s60, s25
    buffer_load_dwordx4 v3, s[52:55], s60 offen lds
    s_add_u32 m0, m0, s24
    s_add_u32 s60, s60, s25
    buffer_load_dwordx4 v2, s[52:55], s60 offen lds
    s_add_u32 m0, m0, s24
    s_add_u32 s60, s60, s25
    buffer_load_dwordx4 v3, s[52:55], s60 offen lds
    s_add_u32 m0, m0, s24
    s_add_u32 s60, s60, s25
    buffer_load_dwordx4 v2, s[52:55], s60 offen lds
    s_add_u32 m0, m0, s24
    s_add_u32 s60, s60, s25
    buffer_load_dwordx4 v3, s[52:55], s60 offen lds
    ds_read_b128 v[12:15], v4 offset:49152
    ds_read_b128 v[16:19], v6 offset:640
    s_waitcnt lgkmcnt(0)
    v_lshlrev_b32 v100, 16, v12
    v_lshlrev_b32 v101, 16, v16
    v_and_b32 v102, 0xffff0000, v12
    v_and_b32 v103, 0xffff0000, v16
    v_fmac_f32 v7, v100, v101
    v_fmac_f32 v7, v102, v103
    v_lshlrev_b32 v100, 16, v13
    v_lshlrev_b32 v101, 16, v17
    v_and_b32 v102, 0xffff0000, v13
    v_and_b32 v103, 0xffff0000, v17
    v_fmac_f32 v7, v100, v101
    v_fmac_f32 v7, v102, v103
    v_lshlrev_b32 v100, 16, v14
    v_lshlrev_b32 v101, 16, v18
    v_and_b32 v102, 0xffff0000, v14
    v_and_b32 v103, 0xffff0000, v18
    v_fmac_f32 v7, v100, v101
    v_fmac_f32 v7, v102, v103
    v_lshlrev_b32 v100, 16, v15
    v_lshlrev_b32 v101, 16, v19
    v_and_b32 v102, 0xffff0000, v15
    v_and_b32 v103, 0xffff0000, v19
    v_fmac_f32 v7, v100, v101
    v_fmac_f32 v7, v102, v103
    s_waitcnt vmcnt(16)
    s_barrier
    s_add_u32 s29, s28, 8
    s_sub_u32 s61, s29, 10
    s_min_u32 s29, s29, s61
    s_mul_i32 s60, s29, s27
    s_add_u32 m0, s62, 0xc000
    s_nop 0
    buffer_load_dwordx4 v2, s[48:51], s60 offen lds
    s_add_u32 m0, m0, s24
    s_add_u32 s60, s60, s25
    buffer_load_dwordx4 v3, s[48:51], s60 offen lds
    s_add_u32 m0, m0, s24
    s_add_u32 s60, s60, s25
    buffer_load_dwordx4 v2, s[48:51], s60 offen lds
    s_add_u32 m0, m0, s24
    s_add_u32 s60, s60, s25
    buffer_load_dwordx4 v3, s[48:51], s60 offen lds
    s_add_u32 m0, m0, s24
    s_add_u32 s60, s60, s25
    buffer_load_dwordx4 v2, s[48:51], s60 offen lds
    s_add_u32 m0, m0, s24
    s_add_u32 s60, s60, s25
    buffer_load_dwordx4 v3, s[48:51], s60 offen lds
    s_add_u32 m0, m0, s24
    s_add_u32 s60, s60, s25
    buffer_load_dwordx4 v2, s[48:51], s60 offen lds
    s_add_u32 m0, m0, s24
    s_add_u32 s60, s60, s25
    buffer_load_dwordx4 v3, s[48:51], s60 offen lds
    s_add_u32 m0, m0, s24
    s_add_u32 s60, s60, s26
    buffer_load_dwordx4 v2, s[52:55], s60 offen lds
    s_add_u32 m0, m0, s24
    s_add_u32 s60, s60, s25
    buffer_load_dwordx4 v3, s[52:55], s60 offen lds
    s_add_u32 m0, m0, s24
    s_add_u32 s60, s60, s25
    buffer_load_dwordx4 v2, s[52:55], s60 offen lds
    s_add_u32 m0, m0, s24
    s_add_u32 s60, s60, s25
    buffer_load_dwordx4 v3, s[52:55], s60 offen lds
    s_add_u32 m0, m0, s24
    s_add_u32 s60, s60, s25
    buffer_load_dwordx4 v2, s[52:55], s60 offen lds
    s_add_u32 m0, m0, s24
    s_add_u32 s60, s60, s25
    buffer_load_dwordx4 v3, s[52:55], s60 offen lds
    s_add_u32 m0, m0, s24
    s_add_u32 s60, s60, s25
    buffer_load_dwordx4 v2, s[52:55], s60 offen lds
    s_add_u32 m0, m0, s24
    s_add_u32 s60, s60, s25
    buffer_load_dwordx4 v3, s[52:55], s60 offen lds
    ds_read_b128 v[12:15], v4 offset:0
    ds_read_b128 v[16:19], v6 offset:768
    s_waitcnt lgkmcnt(0)
    v_lshlrev_b32 v100, 16, v12
    v_lshlrev_b32 v101, 16, v16
    v_and_b32 v102, 0xffff0000, v12
    v_and_b32 v103, 0xffff0000, v16
    v_fmac_f32 v7, v100, v101
    v_fmac_f32 v7, v102, v103
    v_lshlrev_b32 v100, 16, v13
    v_lshlrev_b32 v101, 16, v17
    v_and_b32 v102, 0xffff0000, v13
    v_and_b32 v103, 0xffff0000, v17
    v_fmac_f32 v7, v100, v101
    v_fmac_f32 v7, v102, v103
    v_lshlrev_b32 v100, 16, v14
    v_lshlrev_b32 v101, 16, v18
    v_and_b32 v102, 0xffff0000, v14
    v_and_b32 v103, 0xffff0000, v18
    v_fmac_f32 v7, v100, v101
    v_fmac_f32 v7, v102, v103
    v_lshlrev_b32 v100, 16, v15
    v_lshlrev_b32 v101, 16, v19
    v_and_b32 v102, 0xffff0000, v15
    v_and_b32 v103, 0xffff0000, v19
    v_fmac_f32 v7, v100, v101
    v_fmac_f32 v7, v102, v103
    s_waitcnt vmcnt(16)
    s_barrier
    s_add_u32 s29, s28, 9
    s_sub_u32 s61, s29, 10
    s_min_u32 s29, s29, s61
    s_mul_i32 s60, s29, s27
    s_add_u32 m0, s62, 0x0
    s_nop 0
    buffer_load_dwordx4 v2, s[48:51], s60 offen lds
    s_add_u32 m0, m0, s24
    s_add_u32 s60, s60, s25
    buffer_load_dwordx4 v3, s[48:51], s60 offen lds
    s_add_u32 m0, m0, s24
    s_add_u32 s60, s60, s25
    buffer_load_dwordx4 v2, s[48:51], s60 offen lds
    s_add_u32 m0, m0, s24
    s_add_u32 s60, s60, s25
    buffer_load_dwordx4 v3, s[48:51], s60 offen lds
    s_add_u32 m0, m0, s24
    s_add_u32 s60, s60, s25
    buffer_load_dwordx4 v2, s[48:51], s60 offen lds
    s_add_u32 m0, m0, s24
    s_add_u32 s60, s60, s25
    buffer_load_dwordx4 v3, s[48:51], s60 offen lds
    s_add_u32 m0, m0, s24
    s_add_u32 s60, s60, s25
    buffer_load_dwordx4 v2, s[48:51], s60 offen lds
    s_add_u32 m0, m0, s24
    s_add_u32 s60, s60, s25
    buffer_load_dwordx4 v3, s[48:51], s60 offen lds
    s_add_u32 m0, m0, s24
    s_add_u32 s60, s60, s26
    buffer_load_dwordx4 v2, s[52:55], s60 offen lds
    s_add_u32 m0, m0, s24
    s_add_u32 s60, s60, s25
    buffer_load_dwordx4 v3, s[52:55], s60 offen lds
    s_add_u32 m0, m0, s24
    s_add_u32 s60, s60, s25
    buffer_load_dwordx4 v2, s[52:55], s60 offen lds
    s_add_u32 m0, m0, s24
    s_add_u32 s60, s60, s25
    buffer_load_dwordx4 v3, s[52:55], s60 offen lds
    s_add_u32 m0, m0, s24
    s_add_u32 s60, s60, s25
    buffer_load_dwordx4 v2, s[52:55], s60 offen lds
    s_add_u32 m0, m0, s24
    s_add_u32 s60, s60, s25
    buffer_load_dwordx4 v3, s[52:55], s60 offen lds
    s_add_u32 m0, m0, s24
    s_add_u32 s60, s60, s25
    buffer_load_dwordx4 v2, s[52:55], s60 offen lds
    s_add_u32 m0, m0, s24
    s_add_u32 s60, s60, s25
    buffer_load_dwordx4 v3, s[52:55], s60 offen lds
    ds_read_b128 v[12:15], v5 offset:0
    ds_read_b128 v[16:19], v6 offset:896
    s_waitcnt lgkmcnt(0)
    v_lshlrev_b32 v100, 16, v12
    v_lshlrev_b32 v101, 16, v16
    v_and_b32 v102, 0xffff0000, v12
    v_and_b32 v103, 0xffff0000, v16
    v_fmac_f32 v7, v100, v101
    v_fmac_f32 v7, v102, v103
    v_lshlrev_b32 v100, 16, v13
    v_lshlrev_b32 v101, 16, v17
    v_and_b32 v102, 0xffff0000, v13
    v_and_b32 v103, 0xffff0000, v17
    v_fmac_f32 v7, v100, v101
    v_fmac_f32 v7, v102, v103
    v_lshlrev_b32 v100, 16, v14
    v_lshlrev_b32 v101, 16, v18
    v_and_b32 v102, 0xffff0000, v14
    v_and_b32 v103, 0xffff0000, v18
    v_fmac_f32 v7, v100, v101
    v_fmac_f32 v7, v102, v103
    v_lshlrev_b32 v100, 16, v15
    v_lshlrev_b32 v101, 16, v19
    v_and_b32 v102, 0xffff0000, v15
    v_and_b32 v103, 0xffff0000, v19
    v_fmac_f32 v7, v100, v101
    v_fmac_f32 v7, v102, v103
    s_waitcnt vmcnt(16)
    s_barrier
    ds_read_b128 v[12:15], v4 offset:49152
    ds_read_b128 v[16:19], v6 offset:1024
    s_waitcnt lgkmcnt(0)
    v_lshlrev_b32 v100, 16, v12
    v_lshlrev_b32 v101, 16, v16
    v_and_b32 v102, 0xffff0000, v12
    v_and_b32 v103, 0xffff0000, v16
    v_fmac_f32 v7, v100, v101
    v_fmac_f32 v7, v102, v103
    v_lshlrev_b32 v100, 16, v13
    v_lshlrev_b32 v101, 16, v17
    v_and_b32 v102, 0xffff0000, v13
    v_and_b32 v103, 0xffff0000, v17
    v_fmac_f32 v7, v100, v101
    v_fmac_f32 v7, v102, v103
    v_lshlrev_b32 v100, 16, v14
    v_lshlrev_b32 v101, 16, v18
    v_and_b32 v102, 0xffff0000, v14
    v_and_b32 v103, 0xffff0000, v18
    v_fmac_f32 v7, v100, v101
    v_fmac_f32 v7, v102, v103
    v_lshlrev_b32 v100, 16, v15
    v_lshlrev_b32 v101, 16, v19
    v_and_b32 v102, 0xffff0000, v15
    v_and_b32 v103, 0xffff0000, v19
    v_fmac_f32 v7, v100, v101
    v_fmac_f32 v7, v102, v103
    s_waitcnt vmcnt(0)
    s_barrier
    ds_read_b128 v[12:15], v4 offset:0
    ds_read_b128 v[16:19], v6 offset:1152
    s_xor_b32 s66, s7, 0
    s_add_u32 s66, s66, s65
    s_cmp_ge_u32 s66, 54
    s_cselect_b32 s67, 54, 0
    s_sub_u32 s66, s66, s67
    s_mul_i32 s66, s66, 40960
    buffer_load_dwordx4 v[108:111], v237, s[72:75], s66 offen offset:0 sc1
    buffer_load_dwordx4 v[112:115], v237, s[72:75], s66 offen offset:1024 sc1
    buffer_load_dwordx4 v[116:119], v237, s[72:75], s66 offen offset:2048 sc1
    buffer_load_dwordx4 v[120:123], v237, s[72:75], s66 offen offset:3072 sc1
    buffer_load_dwordx4 v[124:127], v238, s[72:75], s66 offen offset:0 sc1
    s_xor_b32 s66, s7, 4
    s_add_u32 s66, s66, s65
    s_cmp_ge_u32 s66, 54
    s_cselect_b32 s67, 54, 0
    s_sub_u32 s66, s66, s67
    s_mul_i32 s66, s66, 40960
    buffer_load_dwordx4 v[128:131], v237, s[72:75], s66 offen offset:0 sc1
    buffer_load_dwordx4 v[132:135], v237, s[72:75], s66 offen offset:1024 sc1
    buffer_load_dwordx4 v[136:139], v237, s[72:75], s66 offen offset:2048 sc1
    buffer_load_dwordx4 v[140:143], v237, s[72:75], s66 offen offset:3072 sc1
    buffer_load_dwordx4 v[144:147], v238, s[72:75], s66 offen offset:0 sc1
    s_xor_b32 s66, s7, 8
    s_add_u32 s66, s66, s65
    s_cmp_ge_u32 s66, 54
    s_cselect_b32 s67, 54, 0
    s_sub_u32 s66, s66, s67
    s_mul_i32 s66, s66, 40960
    buffer_load_dwordx4 v[148:151], v237, s[72:75], s66 offen offset:0 sc1
    buffer_load_dwordx4 v[152:155], v237, s[72:75], s66 offen offset:1024 sc1
    buffer_load_dwordx4 v[156:159], v237, s[72:75], s66 offen offset:2048 sc1
    buffer_load_dwordx4 v[160:163], v237, s[72:75], s66 offen offset:3072 sc1
    buffer_load_dwordx4 v[164:167], v238, s[72:75], s66 offen offset:0 sc1
    s_xor_b32 s66, s7, 12
    s_add_u32 s66, s66, s65
    s_cmp_ge_u32 s66, 54
    s_cselect_b32 s67, 54, 0
    s_sub_u32 s66, s66, s67
    s_mul_i32 s66, s66, 40960
    buffer_load_dwordx4 v[168:171], v237, s[72:75], s66 offen offset:0 sc1
    buffer_load_dwordx4 v[172:175], v237, s[72:75], s66 offen offset:1024 sc1
    buffer_load_dwordx4 v[176:179], v237, s[72:75], s66 offen offset:2048 sc1
    buffer_load_dwordx4 v[180:183], v237, s[72:75], s66 offen offset:3072 sc1
    buffer_load_dwordx4 v[184:187], v238, s[72:75], s66 offen offset:0 sc1
    s_xor_b32 s66, s7, 16
    s_add_u32 s66, s66, s65
    s_cmp_ge_u32 s66, 54
    s_cselect_b32 s67, 54, 0
    s_sub_u32 s66, s66, s67
    s_mul_i32 s66, s66, 40960
    s_add_u32 m0, s69, 49152
    s_nop 0
    buffer_load_dwordx4 v237, s[72:75], s66 offen offset:0 sc1 lds
    buffer_load_dwordx4 v237, s[72:75], s66 offen offset:1024 sc1 lds
    buffer_load_dwordx4 v237, s[72:75], s66 offen offset:2048 sc1 lds
    buffer_load_dwordx4 v237, s[72:75], s66 offen offset:3072 sc1 lds
    s_add_u32 m0, s69, 53248
    s_nop 0
    buffer_load_dwordx4 v238, s[72:75], s66 offen offset:0 sc1 lds
    s_xor_b32 s66, s7, 20
    s_add_u32 s66, s66, s65
    s_cmp_ge_u32 s66, 54
    s_cselect_b32 s67, 54, 0
    s_sub_u32 s66, s66, s67
    s_mul_i32 s66, s66, 40960
    s_add_u32 m0, s69, 69632
    s_nop 0
    buffer_load_dwordx4 v237, s[72:75], s66 offen offset:0 sc1 lds
    buffer_load_dwordx4 v237, s[72:75], s66 offen offset:1024 sc1 lds
    buffer_load_dwordx4 v237, s[72:75], s66 offen offset:2048 sc1 lds
    buffer_load_dwordx4 v237, s[72:75], s66 offen offset:3072 sc1 lds
    s_add_u32 m0, s69, 73728
    s_nop 0
    buffer_load_dwordx4 v238, s[72:75], s66 offen offset:0 sc1 lds
    s_waitcnt lgkmcnt(0)
    v_lshlrev_b32 v100, 16, v12
    v_lshlrev_b32 v101, 16, v16
    v_and_b32 v102, 0xffff0000, v12
    v_and_b32 v103, 0xffff0000, v16
    v_fmac_f32 v7, v100, v101
    v_fmac_f32 v7, v102, v103
    v_lshlrev_b32 v100, 16, v13
    v_lshlrev_b32 v101, 16, v17
    v_and_b32 v102, 0xffff0000, v13
    v_and_b32 v103, 0xffff0000, v17
    v_fmac_f32 v7, v100, v101
    v_fmac_f32 v7, v102, v103
    v_lshlrev_b32 v100, 16, v14
    v_lshlrev_b32 v101, 16, v18
    v_and_b32 v102, 0xffff0000, v14
    v_and_b32 v103, 0xffff0000, v18
    v_fmac_f32 v7, v100, v101
    v_fmac_f32 v7, v102, v103
    v_lshlrev_b32 v100, 16, v15
    v_lshlrev_b32 v101, 16, v19
    v_and_b32 v102, 0xffff0000, v15
    v_and_b32 v103, 0xffff0000, v19
    v_fmac_f32 v7, v100, v101
    v_fmac_f32 v7, v102, v103
    s_branch K_lend
K_svc:
    s_mov_b32 s56, s36
    s_mov_b32 s57, s37
    s_mov_b32 s58, 0x500
    s_mov_b32 s59, 0x00020000
    v_add_u32 v12, 0, v237
    v_subrev_u32 v13, 1280, v12
    v_min_u32 v12, v12, v13
    v_subrev_u32 v13, 1280, v12
    s_mov_b32 m0, 159744
    v_min_u32 v12, v12, v13
    buffer_load_dwordx4 v12, s[56:59], 0 offen lds
    v_add_u32 v12, 1024, v237
    v_subrev_u32 v13, 1280, v12
    v_min_u32 v12, v12, v13
    v_subrev_u32 v13, 1280, v12
    s_mov_b32 m0, 160768
    v_min_u32 v12, v12, v13
    buffer_load_dwordx4 v12, s[56:59], 0 offen lds
    v_add_u32 v12, 2048, v237
    v_subrev_u32 v13, 1280, v12
    v_min_u32 v12, v12, v13
    v_subrev_u32 v13, 1280, v12
    s_mov_b32 m0, 161792
    v_min_u32 v12, v12, v13
    buffer_load_dwordx4 v12, s[56:59], 0 offen lds
    s_add_u32 s12, s42, 0x1500000
    s_addc_u32 s13, s43, 0
    s_mov_b32 s14, 0xa0000
    s_mov_b32 s15, 0x00020000
    s_lshl_b32 s65, s9, 2
    s_add_u32 s65, s65, s10
    s_and_b32 s65, s65, 31
    s_lshl_b32 s11, s65, 10
    v_add_u32 v4, s11, v237
    v_add_u32 v5, 0x18000, v4
    s_and_b32 s11, s10, 1
    s_lshl_b32 s11, s11, 2
    v_lshrrev_b32 v12, 4, v1
    v_add_u32 v12, s11, v12
    v_and_b32 v13, 7, v1
    v_xor_b32 v12, v12, v13
    s_lshl_b32 s11, s28, 7
    s_add_u32 s11, s11, 159744
    v_lshl_add_u32 v6, v12, 4, s11
    v_mov_b32 v7, 0
    s_lshl_b32 s64, s8, 5
    s_add_u32 s64, s64, s65
    s_lshr_b32 s5, s64, 3
    s_lshl_b32 s5, s5, 6
    s_and_b32 s11, s65, 7
    s_add_u32 s5, s5, s11
    s_add_u32 s5, s5, 54
    s_lshl_b32 s5, s5, 7
    s_lshl_b32 s64, s64, 5
    s_cmp_lt_u32 s9, 8
    s_cselect_b32 s64, s64, 0x1000000
    s_cselect_b32 s5, s5, 0x1000000
    s_mul_i32 s70, s8, 27
    s_add_u32 s70, s70, s9
    s_mul_i32 s11, s70, 3641
    s_lshr_b32 s11, s11, 16
    s_mul_i32 s69, s11, 18
    s_sub_u32 s69, s70, s69
    s_mul_i32 s69, s69, 3
    s_cmp_ge_u32 s70, 180
    s_cselect_b32 s69, 60, s69
    s_mul_i32 s71, s69, 10
    s_add_u32 s71, s71, s11
    s_lshl_b32 s71, s71, 12
    s_mul_i32 s69, s69, 40960
    s_lshl_b32 s22, s11, 7
    s_add_u32 s22, s22, s69
    v_lshrrev_b32 v9, 3, v1
    v_mul_u32_u24 v9, 1280, v9
    v_lshl_add_u32 v9, v13, 4, v9
    v_lshrrev_b32 v10, 2, v1
    v_lshlrev_b32 v10, 7, v10
    v_and_b32 v12, 3, v1
    v_lshl_add_u32 v10, v12, 3, v10
    v_add_u32 v10, 147456, v10
    s_lshl_b32 s21, s70, 13
    v_add_u32 v36, s21, v237
    v_subrev_u32 v37, 2, v36
    s_lshr_b32 s11, s70, 5
    s_lshl_b32 s11, s11, 12
    s_add_u32 s11, s11, 0x40000
    v_min_u32 v241, 31, v1
    v_lshl_add_u32 v241, v241, 7, s11
    s_waitcnt vmcnt(0)
    s_barrier
    s_setprio 2
    ds_read_b128 v[12:15], v4 offset:0
    ds_read_b128 v[16:19], v6 offset:0
    s_mov_b32 s72, s40
    s_mov_b32 s73, s41
    s_mov_b32 s74, 0x100
    s_mov_b32 s75, 0x00020000
    s_and_b32 s11, s4, 1
    s_lshl_b32 s11, s11, 7
    buffer_load_dwordx2 v[250:251], v252, s[72:75], s11 offen sc1
    s_mov_b32 s56, s34
    s_mov_b32 s57, s35
    s_mov_b32 s58, 0x21c000
    s_mov_b32 s59, 0x00020000
    s_mov_b32 m0, 147456
    s_nop 0
    buffer_load_dwordx4 v9, s[56:59], s22 offen lds
    s_mov_b32 m0, 148480
    s_add_u32 s22, s22, 10240
    buffer_load_dwordx4 v9, s[56:59], s22 offen lds
    s_mov_b32 m0, 149504
    s_add_u32 s22, s22, 10240
    buffer_load_dwordx4 v9, s[56:59], s22 offen lds
    s_mov_b32 m0, 150528
    s_add_u32 s22, s22, 10240
    buffer_load_dwordx4 v9, s[56:59], s22 offen lds
    s_mov_b32 m0, 151552
    s_add_u32 s22, s22, 10240
    buffer_load_dwordx4 v9, s[56:59], s22 offen lds
    s_mov_b32 m0, 152576
    s_add_u32 s22, s22, 10240
    buffer_load_dwordx4 v9, s[56:59], s22 offen lds
    s_mov_b32 m0, 153600
    s_add_u32 s22, s22, 10240
    buffer_load_dwordx4 v9, s[56:59], s22 offen lds
    s_mov_b32 m0, 154624
    s_add_u32 s22, s22, 10240
    buffer_load_dwordx4 v9, s[56:59], s22 offen lds
    s_mov_b32 m0, 155648
    s_add_u32 s22, s22, 10240
    buffer_load_dwordx4 v9, s[56:59], s22 offen lds
    s_mov_b32 m0, 156672
    s_add_u32 s22, s22, 10240
    buffer_load_dwordx4 v9, s[56:59], s22 offen lds
    s_mov_b32 m0, 157696
    s_add_u32 s22, s22, 10240
    buffer_load_dwordx4 v9, s[56:59], s22 offen lds
    s_mov_b32 m0, 158720
    s_add_u32 s22, s22, 10240
    buffer_load_dwordx4 v9, s[56:59], s22 offen lds
    s_waitcnt lgkmcnt(0)
    v_lshlrev_b32 v100, 16, v12
    v_lshlrev_b32 v101, 16, v16
    v_and_b32 v102, 0xffff0000, v12
    v_and_b32 v103, 0xffff0000, v16
    v_fmac_f32 v7, v100, v101
    v_fmac_f32 v7, v102, v103
    v_lshlrev_b32 v100, 16, v13
    v_lshlrev_b32 v101, 16, v17
    v_and_b32 v102, 0xffff0000, v13
    v_and_b32 v103, 0xffff0000, v17
    v_fmac_f32 v7, v100, v101
    v_fmac_f32 v7, v102, v103
    v_lshlrev_b32 v100, 16, v14
    v_lshlrev_b32 v101, 16, v18
    v_and_b32 v102, 0xffff0000, v14
    v_and_b32 v103, 0xffff0000, v18
    v_fmac_f32 v7, v100, v101
    v_fmac_f32 v7, v102, v103
    v_lshlrev_b32 v100, 16, v15
    v_lshlrev_b32 v101, 16, v19
    v_and_b32 v102, 0xffff0000, v15
    v_and_b32 v103, 0xffff0000, v19
    v_fmac_f32 v7, v100, v101
    v_fmac_f32 v7, v102, v103
    s_barrier
    ds_read_b128 v[12:15], v5 offset:0
    ds_read_b128 v[16:19], v6 offset:128
    s_waitcnt lgkmcnt(0)
    v_lshlrev_b32 v100, 16, v12
    v_lshlrev_b32 v101, 16, v16
    v_and_b32 v102, 0xffff0000, v12
    v_and_b32 v103, 0xffff0000, v16
    v_fmac_f32 v7, v100, v101
    v_fmac_f32 v7, v102, v103
    v_lshlrev_b32 v100, 16, v13
    v_lshlrev_b32 v101, 16, v17
    v_and_b32 v102, 0xffff0000, v13
    v_and_b32 v103, 0xffff0000, v17
    v_fmac_f32 v7, v100, v101
    v_fmac_f32 v7, v102, v103
    v_lshlrev_b32 v100, 16, v14
    v_lshlrev_b32 v101, 16, v18
    v_and_b32 v102, 0xffff0000, v14
    v_and_b32 v103, 0xffff0000, v18
    v_fmac_f32 v7, v100, v101
    v_fmac_f32 v7, v102, v103
    v_lshlrev_b32 v100, 16, v15
    v_lshlrev_b32 v101, 16, v19
    v_and_b32 v102, 0xffff0000, v15
    v_and_b32 v103, 0xffff0000, v19
    v_fmac_f32 v7, v100, v101
    v_fmac_f32 v7, v102, v103
    s_waitcnt vmcnt(12)
    s_and_b32 s11, s4, 1
    s_lshl_b32 s11, s11, 7
    s_mov_b32 s69, 0x4000
GOR_3:
    v_cmp_ne_u32 vcc, 0, v250
    s_cbranch_vccnz GOD_4
    s_sleep 4
    buffer_load_dwordx2 v[250:251], v252, s[72:75], s11 offen sc1
    s_waitcnt vmcnt(0)
    s_sub_u32 s69, s69, 1
    s_cbranch_scc0 GOR_3
GOD_4:
    ds_write_b64 v254, v[250:251] offset:8
    s_waitcnt lgkmcnt(0)
    s_barrier
    ds_read_b128 v[12:15], v4 offset:49152
    ds_read_b128 v[16:19], v6 offset:256
    ds_read_b64 v[250:251], v254 offset:8
    s_waitcnt vmcnt(0)
    s_add_u32 s56, s42, 0x800000
    s_addc_u32 s57, s43, 0
    s_mov_b32 s58, 0x21c000
    s_mov_b32 s59, 0x00020000
    ds_read_b64_tr_b16 v[52:53], v10 offset:0
    ds_read_b64_tr_b16 v[54:55], v10 offset:2048
    ds_read_b64_tr_b16 v[56:57], v10 offset:32
    ds_read_b64_tr_b16 v[58:59], v10 offset:2080
    ds_read_b64_tr_b16 v[60:61], v10 offset:64
    ds_read_b64_tr_b16 v[62:63], v10 offset:2112
    ds_read_b64_tr_b16 v[64:65], v10 offset:96
    ds_read_b64_tr_b16 v[66:67], v10 offset:2144
    ds_read_b64_tr_b16 v[68:69], v10 offset:4096
    ds_read_b64_tr_b16 v[70:71], v10 offset:6144
    ds_read_b64_tr_b16 v[72:73], v10 offset:4128
    ds_read_b64_tr_b16 v[74:75], v10 offset:6176
    ds_read_b64_tr_b16 v[76:77], v10 offset:4160
    ds_read_b64_tr_b16 v[78:79], v10 offset:6208
    ds_read_b64_tr_b16 v[80:81], v10 offset:4192
    ds_read_b64_tr_b16 v[82:83], v10 offset:6240
    ds_read_b64_tr_b16 v[84:85], v10 offset:8192
    ds_read_b64_tr_b16 v[86:87], v10 offset:10240
    ds_read_b64_tr_b16 v[88:89], v10 offset:8224
    ds_read_b64_tr_b16 v[90:91], v10 offset:10272
    ds_read_b64_tr_b16 v[92:93], v10 offset:8256
    ds_read_b64_tr_b16 v[94:95], v10 offset:10304
    ds_read_b64_tr_b16 v[96:97], v10 offset:8288
    ds_read_b64_tr_b16 v[98:99], v10 offset:10336
    s_waitcnt lgkmcnt(14)
    buffer_store_dwordx4 v[52:55], v237, s[56:59], s71 offen offset:0 sc1
    buffer_store_dwordx4 v[56:59], v237, s[56:59], s71 offen offset:1024 sc1
    buffer_store_dwordx4 v[60:63], v237, s[56:59], s71 offen offset:2048 sc1
    buffer_store_dwordx4 v[64:67], v237, s[56:59], s71 offen offset:3072 sc1
    s_waitcnt lgkmcnt(8)
    s_add_u32 s71, s71, 40960
    buffer_store_dwordx4 v[68:71], v237, s[56:59], s71 offen offset:0 sc1
    buffer_store_dwordx4 v[72:75], v237, s[56:59], s71 offen offset:1024 sc1
    buffer_store_dwordx4 v[76:79], v237, s[56:59], s71 offen offset:2048 sc1
    buffer_store_dwordx4 v[80:83], v237, s[56:59], s71 offen offset:3072 sc1
    s_waitcnt lgkmcnt(0)
    s_add_u32 s71, s71, 40960
    buffer_store_dwordx4 v[84:87], v237, s[56:59], s71 offen offset:0 sc1
    buffer_store_dwordx4 v[88:91], v237, s[56:59], s71 offen offset:1024 sc1
    buffer_store_dwordx4 v[92:95], v237, s[56:59], s71 offen offset:2048 sc1
    buffer_store_dwordx4 v[96:99], v237, s[56:59], s71 offen offset:3072 sc1
    v_lshlrev_b32 v100, 16, v12
    v_lshlrev_b32 v101, 16, v16
    v_and_b32 v102, 0xffff0000, v12
    v_and_b32 v103, 0xffff0000, v16
    v_fmac_f32 v7, v100, v101
    v_fmac_f32 v7, v102, v103
    v_lshlrev_b32 v100, 16, v13
    v_lshlrev_b32 v101, 16, v17
    v_and_b32 v102, 0xffff0000, v13
    v_and_b32 v103, 0xffff0000, v17
    v_fmac_f32 v7, v100, v101
    v_fmac_f32 v7, v102, v103
    v_lshlrev_b32 v100, 16, v14
    v_lshlrev_b32 v101, 16, v18
    v_and_b32 v102, 0xffff0000, v14
    v_and_b32 v103, 0xffff0000, v18
    v_fmac_f32 v7, v100, v101
    v_fmac_f32 v7, v102, v103
    v_lshlrev_b32 v100, 16, v15
    v_lshlrev_b32 v101, 16, v19
    v_and_b32 v102, 0xffff0000, v15
    v_and_b32 v103, 0xffff0000, v19
    v_fmac_f32 v7, v100, v101
    v_fmac_f32 v7, v102, v103
    s_barrier
    ds_read_b128 v[12:15], v4 offset:0
    ds_read_b128 v[16:19], v6 offset:384
    v_readfirstlane_b32 s0, v250
    v_readfirstlane_b32 s1, v251
    s_lshl_b32 s8, s3, 2
    s_lshr_b32 s9, s4, 3
    s_add_u32 s8, s8, s9
    s_and_b32 s9, s4, 7
    s_mul_i32 s67, s9, 5120
    s_add_u32 s67, s67, 0x800000
    s_add_u32 s72, s42, s67
    s_addc_u32 s73, s43, 0
    s_mov_b32 s74, 0x213400
    s_mov_b32 s75, 0x00020000
    s_mov_b32 s65, s10
    s_and_b32 s7, s8, 3
    s_lshl_b32 s7, s7, 2
    s_mul_i32 s69, s10, 5120
    v_add_u32 v238, 4096, v237
    s_mul_i32 s67, s9, 5
    s_lshr_b32 s67, s67, 2
    s_mul_i32 s67, s67, 2304
    s_add_u32 s67, s67, 0x50000
    v_min_u32 v248, 35, v1
    v_lshl_add_u32 v248, v248, 7, s67
    s_mov_b32 s56, s24
    s_mov_b32 s57, s25
    s_mov_b32 s58, 0x280000
    s_mov_b32 s59, 0x00020000
    s_waitcnt vmcnt(0)
    s_lshl_b32 s11, s70, 7
    s_add_u32 s11, s11, 0x50000
    s_mov_b64 exec, 1
    buffer_store_dwordx2 v[250:251], v252, s[12:15], s11 offen sc1
    s_mov_b64 exec, -1
    s_waitcnt lgkmcnt(0)
    v_lshlrev_b32 v100, 16, v12
    v_lshlrev_b32 v101, 16, v16
    v_and_b32 v102, 0xffff0000, v12
    v_and_b32 v103, 0xffff0000, v16
    v_fmac_f32 v7, v100, v101
    v_fmac_f32 v7, v102, v103
    v_lshlrev_b32 v100, 16, v13
    v_lshlrev_b32 v101, 16, v17
    v_and_b32 v102, 0xffff0000, v13
    v_and_b32 v103, 0xffff0000, v17
    v_fmac_f32 v7, v100, v101
    v_fmac_f32 v7, v102, v103
    v_lshlrev_b32 v100, 16, v14
    v_lshlrev_b32 v101, 16, v18
    v_and_b32 v102, 0xffff0000, v14
    v_and_b32 v103, 0xffff0000, v18
    v_fmac_f32 v7, v100, v101
    v_fmac_f32 v7, v102, v103
    v_lshlrev_b32 v100, 16, v15
    v_lshlrev_b32 v101, 16, v19
    v_and_b32 v102, 0xffff0000, v15
    v_and_b32 v103, 0xffff0000, v19
    v_fmac_f32 v7, v100, v101
    v_fmac_f32 v7, v102, v103
    s_barrier
    ds_read_b128 v[12:15], v5 offset:0
    ds_read_b128 v[16:19], v6 offset:512
    s_waitcnt lgkmcnt(0)
    v_lshlrev_b32 v100, 16, v12
    v_lshlrev_b32 v101, 16, v16
    v_and_b32 v102, 0xffff0000, v12
    v_and_b32 v103, 0xffff0000, v16
    v_fmac_f32 v7, v100, v101
    v_fmac_f32 v7, v102, v103
    v_lshlrev_b32 v100, 16, v13
    v_lshlrev_b32 v101, 16, v17
    v_and_b32 v102, 0xffff0000, v13
    v_and_b32 v103, 0xffff0000, v17
    v_fmac_f32 v7, v100, v101
    v_fmac_f32 v7, v102, v103
    v_lshlrev_b32 v100, 16, v14
    v_lshlrev_b32 v101, 16, v18
    v_and_b32 v102, 0xffff0000, v14
    v_and_b32 v103, 0xffff0000, v18
    v_fmac_f32 v7, v100, v101
    v_fmac_f32 v7, v102, v103
    v_lshlrev_b32 v100, 16, v15
    v_lshlrev_b32 v101, 16, v19
    v_and_b32 v102, 0xffff0000, v15
    v_and_b32 v103, 0xffff0000, v19
    v_fmac_f32 v7, v100, v101
    v_fmac_f32 v7, v102, v103
    s_barrier
    ds_read_b128 v[12:15], v4 offset:49152
    ds_read_b128 v[16:19], v6 offset:640
    s_waitcnt lgkmcnt(0)
    v_lshlrev_b32 v100, 16, v12
    v_lshlrev_b32 v101, 16, v16
    v_and_b32 v102, 0xffff0000, v12
    v_and_b32 v103, 0xffff0000, v16
    v_fmac_f32 v7, v100, v101
    v_fmac_f32 v7, v102, v103
    v_lshlrev_b32 v100, 16, v13
    v_lshlrev_b32 v101, 16, v17
    v_and_b32 v102, 0xffff0000, v13
    v_and_b32 v103, 0xffff0000, v17
    v_fmac_f32 v7, v100, v101
    v_fmac_f32 v7, v102, v103
    v_lshlrev_b32 v100, 16, v14
    v_lshlrev_b32 v101, 16, v18
    v_and_b32 v102, 0xffff0000, v14
    v_and_b32 v103, 0xffff0000, v18
    v_fmac_f32 v7, v100, v101
    v_fmac_f32 v7, v102, v103
    v_lshlrev_b32 v100, 16, v15
    v_lshlrev_b32 v101, 16, v19
    v_and_b32 v102, 0xffff0000, v15
    v_and_b32 v103, 0xffff0000, v19
    v_fmac_f32 v7, v100, v101
    v_fmac_f32 v7, v102, v103
    s_barrier
    ds_read_b128 v[12:15], v4 offset:0
    ds_read_b128 v[16:19], v6 offset:768
    buffer_load_dwordx2 v[244:245], v248, s[12:15], 0 offen sc1
    s_waitcnt lgkmcnt(0)
    v_lshlrev_b32 v100, 16, v12
    v_lshlrev_b32 v101, 16, v16
    v_and_b32 v102, 0xffff0000, v12
    v_and_b32 v103, 0xffff0000, v16
    v_fmac_f32 v7, v100, v101
    v_fmac_f32 v7, v102, v103
    v_lshlrev_b32 v100, 16, v13
    v_lshlrev_b32 v101, 16, v17
    v_and_b32 v102, 0xffff0000, v13
    v_and_b32 v103, 0xffff0000, v17
    v_fmac_f32 v7, v100, v101
    v_fmac_f32 v7, v102, v103
    v_lshlrev_b32 v100, 16, v14
    v_lshlrev_b32 v101, 16, v18
    v_and_b32 v102, 0xffff0000, v14
    v_and_b32 v103, 0xffff0000, v18
    v_fmac_f32 v7, v100, v101
    v_fmac_f32 v7, v102, v103
    v_lshlrev_b32 v100, 16, v15
    v_lshlrev_b32 v101, 16, v19
    v_and_b32 v102, 0xffff0000, v15
    v_and_b32 v103, 0xffff0000, v19
    v_fmac_f32 v7, v100, v101
    v_fmac_f32 v7, v102, v103
    s_waitcnt vmcnt(0)
    s_mov_b32 s11, 0x4000
POLL_5:
    v_cmp_eq_u64 vcc, s[0:1], v[244:245]
    s_cmp_eq_u64 vcc, -1
    s_cbranch_scc1 POLLD_6
    s_sleep 4
    buffer_load_dwordx2 v[244:245], v248, s[12:15], 0 offen sc1
    s_waitcnt vmcnt(0)
    s_sub_u32 s11, s11, 1
    s_cbranch_scc0 POLL_5
POLLD_6:
    s_barrier
    ds_read_b128 v[12:15], v5 offset:0
    ds_read_b128 v[16:19], v6 offset:896
    buffer_load_dwordx2 v[242:243], v241, s[12:15], 0 offen sc1
    s_add_u32 s11, s21, 0
    buffer_load_dwordx4 v[40:43], v252, s[56:59], s11 offen
    s_add_u32 s11, s21, 4096
    buffer_load_dwordx4 v[44:47], v252, s[56:59], s11 offen
    s_waitcnt lgkmcnt(0)
    v_lshlrev_b32 v100, 16, v12
    v_lshlrev_b32 v101, 16, v16
    v_and_b32 v102, 0xffff0000, v12
    v_and_b32 v103, 0xffff0000, v16
    v_fmac_f32 v7, v100, v101
    v_fmac_f32 v7, v102, v103
    v_lshlrev_b32 v100, 16, v13
    v_lshlrev_b32 v101, 16, v17
    v_and_b32 v102, 0xffff0000, v13
    v_and_b32 v103, 0xffff0000, v17
    v_fmac_f32 v7, v100, v101
    v_fmac_f32 v7, v102, v103
    v_lshlrev_b32 v100, 16, v14
    v_lshlrev_b32 v101, 16, v18
    v_and_b32 v102, 0xffff0000, v14
    v_and_b32 v103, 0xffff0000, v18
    v_fmac_f32 v7, v100, v101
    v_fmac_f32 v7, v102, v103
    v_lshlrev_b32 v100, 16, v15
    v_lshlrev_b32 v101, 16, v19
    v_and_b32 v102, 0xffff0000, v15
    v_and_b32 v103, 0xffff0000, v19
    v_fmac_f32 v7, v100, v101
    v_fmac_f32 v7, v102, v103
    s_barrier
    ds_read_b128 v[12:15], v4 offset:49152
    ds_read_b128 v[16:19], v6 offset:1024
    v_mov_b64 v[20:21], 0
    s_mov_b32 m0, 98816
    s_movk_i32 s11, 0
    buffer_load_dwordx4 v36, s[56:59], s11 offen offset:0 lds
    buffer_load_dwordx4 v36, s[56:59], s11 offen offset:1024 lds
    buffer_load_dwordx4 v36, s[56:59], s11 offen offset:2048 lds
    buffer_load_dwordx4 v36, s[56:59], s11 offen offset:3072 lds
    s_mov_b32 m0, 103456
    s_movk_i32 s11, 0
    buffer_load_dwordx4 v37, s[56:59], s11 offen offset:0 lds
    buffer_load_dwordx4 v37, s[56:59], s11 offen offset:1024 lds
    buffer_load_dwordx4 v37, s[56:59], s11 offen offset:2048 lds
    buffer_load_dwordx4 v37, s[56:59], s11 offen offset:3072 lds
    s_mov_b32 m0, 112640
    s_movk_i32 s11, 4096
    buffer_load_dwordx4 v36, s[56:59], s11 offen offset:0 lds
    buffer_load_dwordx4 v36, s[56:59], s11 offen offset:1024 lds
    buffer_load_dwordx4 v36, s[56:59], s11 offen offset:2048 lds
    buffer_load_dwordx4 v36, s[56:59], s11 offen offset:3072 lds
    s_mov_b32 m0, 117280
    s_movk_i32 s11, 4096
    buffer_load_dwordx4 v37, s[56:59], s11 offen offset:0 lds
    buffer_load_dwordx4 v37, s[56:59], s11 offen offset:1024 lds
    buffer_load_dwordx4 v37, s[56:59], s11 offen offset:2048 lds
    buffer_load_dwordx4 v37, s[56:59], s11 offen offset:3072 lds
    v_lshlrev_b32 v22, 3, v1
    v_add_u32 v22, 98304, v22
    v_lshlrev_b32 v23, 2, v1
    v_add_u32 v23, 98304, v23
    ds_write_b64 v22, v[20:21] offset:0
    ds_write_b64 v22, v[20:21] offset:4640
    ds_write_b32 v23, v20 offset:13376
    ds_write_b64 v22, v[20:21] offset:13824
    ds_write_b64 v22, v[20:21] offset:18464
    ds_write_b32 v23, v20 offset:27200
    s_waitcnt vmcnt(16)
    s_mov_b32 s21, 0
    v_cmp_eq_u64 vcc, s[0:1], v[242:243]
    s_cmp_eq_u64 vcc, -1
    s_cbranch_scc0 UT_7
    s_add_u32 s56, s42, 0xc00000
    s_addc_u32 s57, s43, 0
    s_mov_b32 s58, 0x280000
    s_mov_b32 s59, 0x00020000
    s_mov_b32 m0, 107584
    s_movk_i32 s11, 0
    buffer_load_dwordx4 v36, s[56:59], s11 offen offset:0 sc1 lds
    buffer_load_dwordx4 v36, s[56:59], s11 offen offset:1024 sc1 lds
    buffer_load_dwordx4 v36, s[56:59], s11 offen offset:2048 sc1 lds
    buffer_load_dwordx4 v36, s[56:59], s11 offen offset:3072 sc1 lds
    s_mov_b32 m0, 121408
    s_movk_i32 s11, 4096
    buffer_load_dwordx4 v36, s[56:59], s11 offen offset:0 sc1 lds
    buffer_load_dwordx4 v36, s[56:59], s11 offen offset:1024 sc1 lds
    buffer_load_dwordx4 v36, s[56:59], s11 offen offset:2048 sc1 lds
    buffer_load_dwordx4 v36, s[56:59], s11 offen offset:3072 sc1 lds
    s_mov_b32 s21, 1
UT_7:
    v_alignbit_b32 v43, v43, v42, 16
    v_alignbit_b32 v42, v42, v41, 16
    v_alignbit_b32 v41, v41, v40, 16
    v_lshlrev_b32 v40, 16, v40
    v_alignbit_b32 v47, v47, v46, 16
    v_alignbit_b32 v46, v46, v45, 16
    v_alignbit_b32 v45, v45, v44, 16
    v_lshlrev_b32 v44, 16, v44
    s_waitcnt lgkmcnt(6)
    v_lshlrev_b32 v100, 16, v12
    v_lshlrev_b32 v101, 16, v16
    v_and_b32 v102, 0xffff0000, v12
    v_and_b32 v103, 0xffff0000, v16
    v_fmac_f32 v7, v100, v101
    v_fmac_f32 v7, v102, v103
    v_lshlrev_b32 v100, 16, v13
    v_lshlrev_b32 v101, 16, v17
    v_and_b32 v102, 0xffff0000, v13
    v_and_b32 v103, 0xffff0000, v17
    v_fmac_f32 v7, v100, v101
    v_fmac_f32 v7, v102, v103
    v_lshlrev_b32 v100, 16, v14
    v_lshlrev_b32 v101, 16, v18
    v_and_b32 v102, 0xffff0000, v14
    v_and_b32 v103, 0xffff0000, v18
    v_fmac_f32 v7, v100, v101
    v_fmac_f32 v7, v102, v103
    v_lshlrev_b32 v100, 16, v15
    v_lshlrev_b32 v101, 16, v19
    v_and_b32 v102, 0xffff0000, v15
    v_and_b32 v103, 0xffff0000, v19
    v_fmac_f32 v7, v100, v101
    v_fmac_f32 v7, v102, v103
    s_waitcnt lgkmcnt(0)
    s_barrier
    ds_read_b128 v[12:15], v4 offset:0
    ds_read_b128 v[16:19], v6 offset:1152
    s_xor_b32 s66, s7, 0
    s_add_u32 s66, s66, s65
    s_cmp_ge_u32 s66, 54
    s_cselect_b32 s67, 54, 0
    s_sub_u32 s66, s66, s67
    s_mul_i32 s66, s66, 40960
    buffer_load_dwordx4 v[108:111], v237, s[72:75], s66 offen offset:0 sc1
    buffer_load_dwordx4 v[112:115], v237, s[72:75], s66 offen offset:1024 sc1
    buffer_load_dwordx4 v[116:119], v237, s[72:75], s66 offen offset:2048 sc1
    buffer_load_dwordx4 v[120:123], v237, s[72:75], s66 offen offset:3072 sc1
    buffer_load_dwordx4 v[124:127], v238, s[72:75], s66 offen offset:0 sc1
    s_xor_b32 s66, s7, 4
    s_add_u32 s66, s66, s65
    s_cmp_ge_u32 s66, 54
    s_cselect_b32 s67, 54, 0
    s_sub_u32 s66, s66, s67
    s_mul_i32 s66, s66, 40960
    buffer_load_dwordx4 v[128:131], v237, s[72:75], s66 offen offset:0 sc1
    buffer_load_dwordx4 v[132:135], v237, s[72:75], s66 offen offset:1024 sc1
    buffer_load_dwordx4 v[136:139], v237, s[72:75], s66 offen offset:2048 sc1
    buffer_load_dwordx4 v[140:143], v237, s[72:75], s66 offen offset:3072 sc1
    buffer_load_dwordx4 v[144:147], v238, s[72:75], s66 offen offset:0 sc1
    s_xor_b32 s66, s7, 8
    s_add_u32 s66, s66, s65
    s_cmp_ge_u32 s66, 54
    s_cselect_b32 s67, 54, 0
    s_sub_u32 s66, s66, s67
    s_mul_i32 s66, s66, 40960
    buffer_load_dwordx4 v[148:151], v237, s[72:75], s66 offen offset:0 sc1
    buffer_load_dwordx4 v[152:155], v237, s[72:75], s66 offen offset:1024 sc1
    buffer_load_dwordx4 v[156:159], v237, s[72:75], s66 offen offset:2048 sc1
    buffer_load_dwordx4 v[160:163], v237, s[72:75], s66 offen offset:3072 sc1
    buffer_load_dwordx4 v[164:167], v238, s[72:75], s66 offen offset:0 sc1
    s_xor_b32 s66, s7, 12
    s_add_u32 s66, s66, s65
    s_cmp_ge_u32 s66, 54
    s_cselect_b32 s67, 54, 0
    s_sub_u32 s66, s66, s67
    s_mul_i32 s66, s66, 40960
    buffer_load_dwordx4 v[168:171], v237, s[72:75], s66 offen offset:0 sc1
    buffer_load_dwordx4 v[172:175], v237, s[72:75], s66 offen offset:1024 sc1
    buffer_load_dwordx4 v[176:179], v237, s[72:75], s66 offen offset:2048 sc1
    buffer_load_dwordx4 v[180:183], v237, s[72:75], s66 offen offset:3072 sc1
    buffer_load_dwordx4 v[184:187], v238, s[72:75], s66 offen offset:0 sc1
    s_xor_b32 s66, s7, 16
    s_add_u32 s66, s66, s65
    s_cmp_ge_u32 s66, 54
    s_cselect_b32 s67, 54, 0
    s_sub_u32 s66, s66, s67
    s_mul_i32 s66, s66, 40960
    s_add_u32 m0, s69, 49152
    s_nop 0
    buffer_load_dwordx4 v237, s[72:75], s66 offen offset:0 sc1 lds
    buffer_load_dwordx4 v237, s[72:75], s66 offen offset:1024 sc1 lds
    buffer_load_dwordx4 v237, s[72:75], s66 offen offset:2048 sc1 lds
    buffer_load_dwordx4 v237, s[72:75], s66 offen offset:3072 sc1 lds
    s_add_u32 m0, s69, 53248
    s_nop 0
    buffer_load_dwordx4 v238, s[72:75], s66 offen offset:0 sc1 lds
    s_xor_b32 s66, s7, 20
    s_add_u32 s66, s66, s65
    s_cmp_ge_u32 s66, 54
    s_cselect_b32 s67, 54, 0
    s_sub_u32 s66, s66, s67
    s_mul_i32 s66, s66, 40960
    s_add_u32 m0, s69, 69632
    s_nop 0
    buffer_load_dwordx4 v237, s[72:75], s66 offen offset:0 sc1 lds
    buffer_load_dwordx4 v237, s[72:75], s66 offen offset:1024 sc1 lds
    buffer_load_dwordx4 v237, s[72:75], s66 offen offset:2048 sc1 lds
    buffer_load_dwordx4 v237, s[72:75], s66 offen offset:3072 sc1 lds
    s_add_u32 m0, s69, 73728
    s_nop 0
    buffer_load_dwordx4 v238, s[72:75], s66 offen offset:0 sc1 lds
    s_waitcnt lgkmcnt(0)
    v_lshlrev_b32 v100, 16, v12
    v_lshlrev_b32 v101, 16, v16
    v_and_b32 v102, 0xffff0000, v12
    v_and_b32 v103, 0xffff0000, v16
    v_fmac_f32 v7, v100, v101
    v_fmac_f32 v7, v102, v103
    v_lshlrev_b32 v100, 16, v13
    v_lshlrev_b32 v101, 16, v17
    v_and_b32 v102, 0xffff0000, v13
    v_and_b32 v103, 0xffff0000, v17
    v_fmac_f32 v7, v100, v101
    v_fmac_f32 v7, v102, v103
    v_lshlrev_b32 v100, 16, v14
    v_lshlrev_b32 v101, 16, v18
    v_and_b32 v102, 0xffff0000, v14
    v_and_b32 v103, 0xffff0000, v18
    v_fmac_f32 v7, v100, v101
    v_fmac_f32 v7, v102, v103
    v_lshlrev_b32 v100, 16, v15
    v_lshlrev_b32 v101, 16, v19
    v_and_b32 v102, 0xffff0000, v15
    v_and_b32 v103, 0xffff0000, v19
    v_fmac_f32 v7, v100, v101
    v_fmac_f32 v7, v102, v103
    s_cmp_eq_u32 s21, 1
    s_cbranch_scc1 UOK_8
    s_mov_b32 s11, 0x4000
POLL_9:
    v_cmp_eq_u64 vcc, s[0:1], v[242:243]
    s_cmp_eq_u64 vcc, -1
    s_cbranch_scc1 POLLD_10
    s_sleep 2
    buffer_load_dwordx2 v[242:243], v241, s[12:15], 0 offen sc1
    s_waitcnt vmcnt(0)
    s_sub_u32 s11, s11, 1
    s_cbranch_scc0 POLL_9
POLLD_10:
    s_add_u32 s56, s42, 0xc00000
    s_addc_u32 s57, s43, 0
    s_mov_b32 s58, 0x280000
    s_mov_b32 s59, 0x00020000
    s_mov_b32 m0, 107584
    s_movk_i32 s11, 0
    buffer_load_dwordx4 v36, s[56:59], s11 offen offset:0 sc1 lds
    buffer_load_dwordx4 v36, s[56:59], s11 offen offset:1024 sc1 lds
    buffer_load_dwordx4 v36, s[56:59], s11 offen offset:2048 sc1 lds
    buffer_load_dwordx4 v36, s[56:59], s11 offen offset:3072 sc1 lds
    s_mov_b32 m0, 121408
    s_movk_i32 s11, 4096
    buffer_load_dwordx4 v36, s[56:59], s11 offen offset:0 sc1 lds
    buffer_load_dwordx4 v36, s[56:59], s11 offen offset:1024 sc1 lds
    buffer_load_dwordx4 v36, s[56:59], s11 offen offset:2048 sc1 lds
    buffer_load_dwordx4 v36, s[56:59], s11 offen offset:3072 sc1 lds
    s_waitcnt vmcnt(0)
UOK_8:
    s_waitcnt vmcnt(30)
    v_mov_b32 v22, 98304
    v_mov_b32 v23, 4
    ds_write_b128 v22, v[40:43] offset:5152
    ds_write_b128 v22, v[44:47] offset:18976
    ds_write_b32 v254, v23 offset:20
K_lend:
    s_nop 1
    v_add_f32_dpp v7, v7, v7 quad_perm:[1,0,3,2] row_mask:0xf bank_mask:0xf
    s_nop 1
    v_add_f32_dpp v7, v7, v7 quad_perm:[2,3,0,1] row_mask:0xf bank_mask:0xf
    s_nop 1
    v_add_f32_dpp v7, v7, v7 row_half_mirror row_mask:0xf bank_mask:0xf
    v_mul_f32 v7, 0xbfb8aa3b, v7
    v_exp_f32 v7, v7
    v_lshrrev_b32 v8, 3, v1
    v_add_f32 v7, 1.0, v7
    v_rcp_f32 v7, v7
    v_lshlrev_b32 v8, 2, v8
    s_add_u32 s44, s42, 0x1400000
    s_addc_u32 s45, s43, 0
    s_mov_b32 s46, 0x2000
    s_mov_b32 s47, 0x00020000
    s_mov_b32 exec_lo, 0x01010101
    s_mov_b32 exec_hi, 0x01010101
    buffer_store_dword v7, v8, s[44:47], s64 offen sc1
    s_mov_b64 exec, -1
    s_mov_b64 exec, 1
    ds_add_u32 v254, v253 offset:24
    s_mov_b64 exec, -1
    s_mov_b32 s11, 0x40000
SA_11:
    ds_read_b32 v247, v254 offset:24
    s_waitcnt lgkmcnt(0)
    v_cmp_eq_u32 vcc, 8, v247
    s_cbranch_vccnz SAD_12
    s_sleep 2
    s_sub_u32 s11, s11, 1
    s_cbranch_scc0 SA_11
SAD_12:
    s_xor_b32 s66, s7, 24
    s_add_u32 s66, s66, s65
    s_cmp_ge_u32 s66, 54
    s_cselect_b32 s67, 54, 0
    s_sub_u32 s66, s66, s67
    s_mul_i32 s66, s66, 40960
    s_add_u32 m0, s69, 0
    s_nop 0
    buffer_load_dwordx4 v237, s[72:75], s66 offen offset:0 sc1 lds
    buffer_load_dwordx4 v237, s[72:75], s66 offen offset:1024 sc1 lds
    buffer_load_dwordx4 v237, s[72:75], s66 offen offset:2048 sc1 lds
    buffer_load_dwordx4 v237, s[72:75], s66 offen offset:3072 sc1 lds
    s_add_u32 m0, s69, 4096
    s_nop 0
    buffer_load_dwordx4 v238, s[72:75], s66 offen offset:0 sc1 lds
    s_xor_b32 s66, s7, 28
    s_add_u32 s66, s66, s65
    s_cmp_ge_u32 s66, 54
    s_cselect_b32 s67, 54, 0
    s_sub_u32 s66, s66, s67
    s_mul_i32 s66, s66, 40960
    s_add_u32 m0, s69, 20480
    s_nop 0
    buffer_load_dwordx4 v237, s[72:75], s66 offen offset:0 sc1 lds
    buffer_load_dwordx4 v237, s[72:75], s66 offen offset:1024 sc1 lds
    buffer_load_dwordx4 v237, s[72:75], s66 offen offset:2048 sc1 lds
    buffer_load_dwordx4 v237, s[72:75], s66 offen offset:3072 sc1 lds
    s_add_u32 m0, s69, 24576
    s_nop 0
    buffer_load_dwordx4 v238, s[72:75], s66 offen offset:0 sc1 lds
    s_waitcnt vmcnt(10)
    s_mov_b64 exec, 1
    buffer_store_dwordx2 v[250:251], v252, s[12:15], s5 offen sc1
    s_mov_b64 exec, -1
    s_branch K_g2wait
K_comp:
    s_bfe_u32 s65, s10, 0x10001
    s_and_b32 s66, s10, 1
    v_and_b32 v13, 15, v1
    v_lshrrev_b32 v14, 4, v1
    v_bfe_u32 v15, v1, 1, 3
    v_xor_b32 v15, v15, v14
    s_lshl_b32 s11, s65, 14
    v_lshl_add_u32 v12, v13, 7, s11
    v_lshl_add_u32 v2, v15, 4, v12
    v_xor_b32 v15, 4, v15
    v_lshl_add_u32 v3, v15, 4, v12
    v_add_u32 v4, 0x18000, v2
    v_add_u32 v5, 0x18000, v3
    v_bfe_u32 v12, v1, 2, 2
    v_lshl_add_u32 v12, v14, 3, v12
    v_lshlrev_b32 v12, 7, v12
    v_and_b32 v13, 3, v1
    v_lshl_add_u32 v12, v13, 3, v12
    v_add_u32 v12, 0x8000, v12
    v_bfe_u32 v13, v1, 3, 2
    s_lshl_b32 s11, s66, 1
    v_xor_b32 v13, s11, v13
    v_lshl_add_u32 v6, v13, 5, v12
    v_xor_b32 v13, 1, v13
    v_lshl_add_u32 v7, v13, 5, v12
    v_add_u32 v8, 0x18000, v6
    v_add_u32 v9, 0x18000, v7
    s_lshl_b32 s67, s8, 1
    s_add_u32 s67, s67, s65
    s_lshl_b32 s67, s67, 1
    s_lshl_b32 s68, s9, 1
    s_add_u32 s68, s68, s66
    s_lshl_b32 s5, s67, 6
    s_add_u32 s5, s5, s68
    s_lshl_b32 s5, s5, 7
    s_mul_i32 s63, s67, 54
    s_add_u32 s63, s63, s68
    s_lshl_b32 s63, s63, 12
    s_mul_i32 s7, s8, 27
    s_add_u32 s7, s7, s9
    v_lshlrev_b32 v10, 13, v1
    v_add_u32 v11, 221184, v237
    s_waitcnt lgkmcnt(0)
    s_add_u32 s12, s42, 0x1500000
    s_addc_u32 s13, s43, 0
    s_mov_b32 s14, 0xa0000
    s_mov_b32 s15, 0x00020000
    s_mov_b32 s56, s42
    s_mov_b32 s57, s43
    s_mov_b32 s58, 0x6c0000
    s_mov_b32 s59, 0x00020000
    s_mov_b32 s8, 0
    s_mov_b32 s71, 0
    s_mov_b32 s20, 98304
    s_mov_b32 s72, s24
    s_mov_b32 s73, s25
    s_mov_b32 s74, 0x280000
    s_mov_b32 s75, 0x00020000
    s_lshl_b32 s11, s7, 2
    s_load_dword s18, s[26:27], s11
    s_or_b32 s11, s11, 4
    s_load_dword s19, s[26:27], s11
    s_and_b32 s9, s10, 3
    s_xor_b32 s11, s8, 1
    s_lshr_b32 s68, s9, s11
    s_lshl_b32 s66, s7, 1
    s_add_u32 s66, s66, s68
    s_lshl_b32 s66, s66, 12
    s_mul_i32 s67, s68, 13824
    s_add_u32 s67, s67, s20
    v_add_u32 v238, s66, v237
    v_subrev_u32 v239, 2, v238
    v_lshl_add_u32 v246, v1, 7, s66
    s_lshr_b32 s11, s7, 5
    s_lshl_b32 s11, s11, 12
    s_add_u32 s11, s11, 0x40000
    v_min_u32 v248, 31, v1
    v_lshl_add_u32 v248, v248, 7, s11
    s_mov_b32 s68, 0
    s_mul_i32 s65, s7, 1639
    s_lshr_b32 s65, s65, 16
    s_mul_i32 s6, s65, 40
    s_sub_u32 s6, s7, s6
    s_lshl_b32 s65, s65, 2
    s_add_u32 s65, s65, s9
    s_lshl_b32 s65, s65, 6
    s_add_u32 s6, s6, s65
    s_lshl_b32 s6, s6, 3
    s_add_u32 s6, s6, 0x60000
    s_andn2_b32 s65, s9, s8
    s_and_b32 s65, s65, 1
    s_lshl_b32 s65, s65, 8
    s_add_u32 s65, s65, s67
    v_and_b32 v228, 1, v1
    v_xor_b32 v228, 1, v228
    v_mul_u32_u24 v228, 4640, v228
    v_bfe_u32 v204, v1, 1, 3
    v_lshl_add_u32 v228, v204, 6, v228
    v_lshrrev_b32 v204, 4, v1
    v_lshl_add_u32 v228, v204, 4, v228
    s_add_u32 s69, s65, 64
    v_add_u32 v228, s69, v228
    v_and_b32 v205, 15, v1
    v_lshlrev_b32 v205, 2, v205
    v_lshlrev_b32 v229, 4, v204
    v_sub_u32 v229, v229, v205
    s_add_u32 s69, s65, 9340
    v_add_u32 v229, s69, v229
    v_add_u32 v230, 1024, v229
    v_add_u32 v231, 2048, v229
    v_add_u32 v232, 3072, v229
    v_lshl_add_u32 v205, v204, 7, v205
    s_lshl_b32 s65, s9, 10
    s_sub_u32 s65, 12796, s65
    s_add_u32 s65, s65, s20
    v_sub_u32 v233, s65, v205
    s_mul_i32 s65, s8, 5632
    s_add_u32 s65, s65, 8192
    s_mul_i32 s65, s65, s9
    s_xor_b32 s69, s8, 1
    s_mul_i32 s69, s69, 27648
    s_add_u32 s69, s69, s20
    s_add_u32 s65, s65, s69
    v_add_u32 v234, s65, v237
    s_lshl_b32 s65, s9, 11
    s_add_u32 s69, s69, s65
    v_add_u32 v235, s69, v237
    s_lshl_b32 s66, s7, 13
    s_add_u32 s66, s66, s65
    s_mov_b32 s60, 0xbfb8aa3b
    s_mov_b32 s61, 0xbfb8aa3b
    s_waitcnt lgkmcnt(0)
    s_setprio 1
    s_barrier
    ds_read_b64_tr_b16 v[12:13], v6 offset:0
    ds_read_b64_tr_b16 v[14:15], v6 offset:512
    ds_read_b128 v[44:47], v2 offset:0
    ds_read_b64_tr_b16 v[16:17], v7 offset:0
    ds_read_b64_tr_b16 v[18:19], v7 offset:512
    ds_read_b64_tr_b16 v[20:21], v6 offset:8192
    ds_read_b64_tr_b16 v[22:23], v6 offset:8704
    ds_read_b64_tr_b16 v[24:25], v7 offset:8192
    ds_read_b64_tr_b16 v[26:27], v7 offset:8704
    ds_read_b128 v[48:51], v2 offset:2048
    ds_read_b128 v[52:55], v2 offset:4096
    ds_read_b128 v[56:59], v2 offset:6144
    ds_read_b128 v[60:63], v2 offset:8192
    ds_read_b128 v[64:67], v2 offset:10240
    ds_read_b128 v[68:71], v2 offset:12288
    ds_read_b128 v[72:75], v2 offset:14336
    s_waitcnt lgkmcnt(13)
    v_mfma_f32_16x16x32_bf16 v[76:79], v[12:15], v[44:47], 0
    ds_read_b64_tr_b16 v[28:29], v6 offset:4096
    s_waitcnt lgkmcnt(12)
    v_mfma_f32_16x16x32_bf16 v[80:83], v[16:19], v[44:47], 0
    ds_read_b64_tr_b16 v[30:31], v6 offset:4608
    s_waitcnt lgkmcnt(11)
    v_mfma_f32_16x16x32_bf16 v[84:87], v[20:23], v[44:47], 0
    ds_read_b64_tr_b16 v[32:33], v7 offset:4096
    s_waitcnt lgkmcnt(10)
    v_mfma_f32_16x16x32_bf16 v[88:91], v[24:27], v[44:47], 0
    ds_read_b128 v[44:47], v3 offset:0
    s_waitcnt lgkmcnt(10)
    v_mfma_f32_16x16x32_bf16 v[92:95], v[12:15], v[48:51], 0
    ds_read_b64_tr_b16 v[34:35], v7 offset:4608
    v_mfma_f32_16x16x32_bf16 v[96:99], v[16:19], v[48:51], 0
    ds_read_b64_tr_b16 v[36:37], v6 offset:12288
    v_mfma_f32_16x16x32_bf16 v[100:103], v[20:23], v[48:51], 0
    ds_read_b64_tr_b16 v[38:39], v6 offset:12800
    v_mfma_f32_16x16x32_bf16 v[104:107], v[24:27], v[48:51], 0
    ds_read_b128 v[48:51], v3 offset:2048
    s_waitcnt lgkmcnt(13)
    v_mfma_f32_16x16x32_bf16 v[108:111], v[12:15], v[52:55], 0
    ds_read_b64_tr_b16 v[40:41], v7 offset:12288
    v_mfma_f32_16x16x32_bf16 v[112:115], v[16:19], v[52:55], 0
    ds_read_b64_tr_b16 v[42:43], v7 offset:12800
    v_mfma_f32_16x16x32_bf16 v[116:119], v[20:23], v[52:55], 0
    v_mfma_f32_16x16x32_bf16 v[120:123], v[24:27], v[52:55], 0
    ds_read_b128 v[52:55], v3 offset:4096
    s_waitcnt lgkmcnt(14)
    v_mfma_f32_16x16x32_bf16 v[124:127], v[12:15], v[56:59], 0
    v_mfma_f32_16x16x32_bf16 v[128:131], v[16:19], v[56:59], 0
    v_mfma_f32_16x16x32_bf16 v[132:135], v[20:23], v[56:59], 0
    v_mfma_f32_16x16x32_bf16 v[136:139], v[24:27], v[56:59], 0
    ds_read_b128 v[56:59], v3 offset:6144
    s_waitcnt lgkmcnt(14)
    v_mfma_f32_16x16x32_bf16 v[140:143], v[12:15], v[60:63], 0
    v_mfma_f32_16x16x32_bf16 v[144:147], v[16:19], v[60:63], 0
    v_mfma_f32_16x16x32_bf16 v[148:151], v[20:23], v[60:63], 0
    v_mfma_f32_16x16x32_bf16 v[152:155], v[24:27], v[60:63], 0
    ds_read_b128 v[60:63], v3 offset:8192
    s_waitcnt lgkmcnt(14)
    v_mfma_f32_16x16x32_bf16 v[156:159], v[12:15], v[64:67], 0
    v_mfma_f32_16x16x32_bf16 v[160:163], v[16:19], v[64:67], 0
    v_mfma_f32_16x16x32_bf16 v[164:167], v[20:23], v[64:67], 0
    v_mfma_f32_16x16x32_bf16 v[168:171], v[24:27], v[64:67], 0
    ds_read_b128 v[64:67], v3 offset:10240
    s_waitcnt lgkmcnt(14)
    v_mfma_f32_16x16x32_bf16 v[172:175], v[12:15], v[68:71], 0
    v_mfma_f32_16x16x32_bf16 v[176:179], v[16:19], v[68:71], 0
    v_mfma_f32_16x16x32_bf16 v[180:183], v[20:23], v[68:71], 0
    v_mfma_f32_16x16x32_bf16 v[184:187], v[24:27], v[68:71], 0
    ds_read_b128 v[68:71], v3 offset:12288
    s_waitcnt lgkmcnt(14)
    v_mfma_f32_16x16x32_bf16 v[188:191], v[12:15], v[72:75], 0
    v_mfma_f32_16x16x32_bf16 v[192:195], v[16:19], v[72:75], 0
    v_mfma_f32_16x16x32_bf16 v[196:199], v[20:23], v[72:75], 0
    v_mfma_f32_16x16x32_bf16 v[200:203], v[24:27], v[72:75], 0
    ds_read_b128 v[72:75], v3 offset:14336
    s_waitcnt lgkmcnt(12)
    v_mfma_f32_16x16x32_bf16 v[76:79], v[28:31], v[44:47], v[76:79]
    s_waitcnt lgkmcnt(11)
    v_mfma_f32_16x16x32_bf16 v[80:83], v[32:35], v[44:47], v[80:83]
    s_waitcnt lgkmcnt(9)
    v_mfma_f32_16x16x32_bf16 v[84:87], v[36:39], v[44:47], v[84:87]
    s_waitcnt lgkmcnt(6)
    v_mfma_f32_16x16x32_bf16 v[88:91], v[40:43], v[44:47], v[88:91]
    s_waitcnt lgkmcnt(0)
    s_barrier
    ds_read_b128 v[44:47], v4 offset:0
    v_mfma_f32_16x16x32_bf16 v[92:95], v[28:31], v[48:51], v[92:95]
    ds_read_b64_tr_b16 v[12:13], v8 offset:0
    v_mfma_f32_16x16x32_bf16 v[96:99], v[32:35], v[48:51], v[96:99]
    ds_read_b64_tr_b16 v[14:15], v8 offset:512
    v_mfma_f32_16x16x32_bf16 v[100:103], v[36:39], v[48:51], v[100:103]
    ds_read_b64_tr_b16 v[16:17], v9 offset:0
    v_mfma_f32_16x16x32_bf16 v[104:107], v[40:43], v[48:51], v[104:107]
    ds_read_b128 v[48:51], v4 offset:2048
    v_mfma_f32_16x16x32_bf16 v[108:111], v[28:31], v[52:55], v[108:111]
    ds_read_b64_tr_b16 v[18:19], v9 offset:512
    v_mfma_f32_16x16x32_bf16 v[112:115], v[32:35], v[52:55], v[112:115]
    ds_read_b64_tr_b16 v[20:21], v8 offset:8192
    v_mfma_f32_16x16x32_bf16 v[116:119], v[36:39], v[52:55], v[116:119]
    ds_read_b64_tr_b16 v[22:23], v8 offset:8704
    v_mfma_f32_16x16x32_bf16 v[120:123], v[40:43], v[52:55], v[120:123]
    ds_read_b128 v[52:55], v4 offset:4096
    v_mfma_f32_16x16x32_bf16 v[124:127], v[28:31], v[56:59], v[124:127]
    ds_read_b64_tr_b16 v[24:25], v9 offset:8192
    v_mfma_f32_16x16x32_bf16 v[128:131], v[32:35], v[56:59], v[128:131]
    ds_read_b64_tr_b16 v[26:27], v9 offset:8704
    v_mfma_f32_16x16x32_bf16 v[132:135], v[36:39], v[56:59], v[132:135]
    v_mfma_f32_16x16x32_bf16 v[136:139], v[40:43], v[56:59], v[136:139]
    ds_read_b128 v[56:59], v4 offset:6144
    v_mfma_f32_16x16x32_bf16 v[140:143], v[28:31], v[60:63], v[140:143]
    v_mfma_f32_16x16x32_bf16 v[144:147], v[32:35], v[60:63], v[144:147]
    v_mfma_f32_16x16x32_bf16 v[148:151], v[36:39], v[60:63], v[148:151]
    v_mfma_f32_16x16x32_bf16 v[152:155], v[40:43], v[60:63], v[152:155]
    ds_read_b128 v[60:63], v4 offset:8192
    v_mfma_f32_16x16x32_bf16 v[156:159], v[28:31], v[64:67], v[156:159]
    v_mfma_f32_16x16x32_bf16 v[160:163], v[32:35], v[64:67], v[160:163]
    v_mfma_f32_16x16x32_bf16 v[164:167], v[36:39], v[64:67], v[164:167]
    v_mfma_f32_16x16x32_bf16 v[168:171], v[40:43], v[64:67], v[168:171]
    ds_read_b128 v[64:67], v4 offset:10240
    v_mfma_f32_16x16x32_bf16 v[172:175], v[28:31], v[68:71], v[172:175]
    v_mfma_f32_16x16x32_bf16 v[176:179], v[32:35], v[68:71], v[176:179]
    v_mfma_f32_16x16x32_bf16 v[180:183], v[36:39], v[68:71], v[180:183]
    v_mfma_f32_16x16x32_bf16 v[184:187], v[40:43], v[68:71], v[184:187]
    ds_read_b128 v[68:71], v4 offset:12288
    v_mfma_f32_16x16x32_bf16 v[188:191], v[28:31], v[72:75], v[188:191]
    v_mfma_f32_16x16x32_bf16 v[192:195], v[32:35], v[72:75], v[192:195]
    v_mfma_f32_16x16x32_bf16 v[196:199], v[36:39], v[72:75], v[196:199]
    v_mfma_f32_16x16x32_bf16 v[200:203], v[40:43], v[72:75], v[200:203]
    ds_read_b128 v[72:75], v4 offset:14336
    s_waitcnt lgkmcnt(13)
    v_mfma_f32_16x16x32_bf16 v[76:79], v[12:15], v[44:47], v[76:79]
    ds_read_b64_tr_b16 v[28:29], v8 offset:4096
    s_waitcnt lgkmcnt(11)
    v_mfma_f32_16x16x32_bf16 v[80:83], v[16:19], v[44:47], v[80:83]
    ds_read_b64_tr_b16 v[30:31], v8 offset:4608
    s_waitcnt lgkmcnt(10)
    v_mfma_f32_16x16x32_bf16 v[84:87], v[20:23], v[44:47], v[84:87]
    ds_read_b64_tr_b16 v[32:33], v9 offset:4096
    s_waitcnt lgkmcnt(8)
    v_mfma_f32_16x16x32_bf16 v[88:91], v[24:27], v[44:47], v[88:91]
    ds_read_b128 v[44:47], v5 offset:0
    v_mfma_f32_16x16x32_bf16 v[92:95], v[12:15], v[48:51], v[92:95]
    ds_read_b64_tr_b16 v[34:35], v9 offset:4608
    v_mfma_f32_16x16x32_bf16 v[96:99], v[16:19], v[48:51], v[96:99]
    ds_read_b64_tr_b16 v[36:37], v8 offset:12288
    v_mfma_f32_16x16x32_bf16 v[100:103], v[20:23], v[48:51], v[100:103]
    ds_read_b64_tr_b16 v[38:39], v8 offset:12800
    v_mfma_f32_16x16x32_bf16 v[104:107], v[24:27], v[48:51], v[104:107]
    ds_read_b128 v[48:51], v5 offset:2048
    v_mfma_f32_16x16x32_bf16 v[108:111], v[12:15], v[52:55], v[108:111]
    ds_read_b64_tr_b16 v[40:41], v9 offset:12288
    v_mfma_f32_16x16x32_bf16 v[112:115], v[16:19], v[52:55], v[112:115]
    ds_read_b64_tr_b16 v[42:43], v9 offset:12800
    v_mfma_f32_16x16x32_bf16 v[116:119], v[20:23], v[52:55], v[116:119]
    v_mfma_f32_16x16x32_bf16 v[120:123], v[24:27], v[52:55], v[120:123]
    ds_read_b128 v[52:55], v5 offset:4096
    s_waitcnt lgkmcnt(14)
    v_mfma_f32_16x16x32_bf16 v[124:127], v[12:15], v[56:59], v[124:127]
    v_mfma_f32_16x16x32_bf16 v[128:131], v[16:19], v[56:59], v[128:131]
    v_mfma_f32_16x16x32_bf16 v[132:135], v[20:23], v[56:59], v[132:135]
    v_mfma_f32_16x16x32_bf16 v[136:139], v[24:27], v[56:59], v[136:139]
    ds_read_b128 v[56:59], v5 offset:6144
    s_waitcnt lgkmcnt(14)
    v_mfma_f32_16x16x32_bf16 v[140:143], v[12:15], v[60:63], v[140:143]
    v_mfma_f32_16x16x32_bf16 v[144:147], v[16:19], v[60:63], v[144:147]
    v_mfma_f32_16x16x32_bf16 v[148:151], v[20:23], v[60:63], v[148:151]
    v_mfma_f32_16x16x32_bf16 v[152:155], v[24:27], v[60:63], v[152:155]
    ds_read_b128 v[60:63], v5 offset:8192
    s_waitcnt lgkmcnt(14)
    v_mfma_f32_16x16x32_bf16 v[156:159], v[12:15], v[64:67], v[156:159]
    v_mfma_f32_16x16x32_bf16 v[160:163], v[16:19], v[64:67], v[160:163]
    v_mfma_f32_16x16x32_bf16 v[164:167], v[20:23], v[64:67], v[164:167]
    v_mfma_f32_16x16x32_bf16 v[168:171], v[24:27], v[64:67], v[168:171]
    ds_read_b128 v[64:67], v5 offset:10240
    s_waitcnt lgkmcnt(14)
    v_mfma_f32_16x16x32_bf16 v[172:175], v[12:15], v[68:71], v[172:175]
    v_mfma_f32_16x16x32_bf16 v[176:179], v[16:19], v[68:71], v[176:179]
    v_mfma_f32_16x16x32_bf16 v[180:183], v[20:23], v[68:71], v[180:183]
    v_mfma_f32_16x16x32_bf16 v[184:187], v[24:27], v[68:71], v[184:187]
    ds_read_b128 v[68:71], v5 offset:12288
    s_waitcnt lgkmcnt(14)
    v_mfma_f32_16x16x32_bf16 v[188:191], v[12:15], v[72:75], v[188:191]
    v_mfma_f32_16x16x32_bf16 v[192:195], v[16:19], v[72:75], v[192:195]
    v_mfma_f32_16x16x32_bf16 v[196:199], v[20:23], v[72:75], v[196:199]
    v_mfma_f32_16x16x32_bf16 v[200:203], v[24:27], v[72:75], v[200:203]
    ds_read_b128 v[72:75], v5 offset:14336
    s_waitcnt lgkmcnt(12)
    v_mfma_f32_16x16x32_bf16 v[76:79], v[28:31], v[44:47], v[76:79]
    s_waitcnt lgkmcnt(11)
    v_mfma_f32_16x16x32_bf16 v[80:83], v[32:35], v[44:47], v[80:83]
    s_waitcnt lgkmcnt(9)
    v_mfma_f32_16x16x32_bf16 v[84:87], v[36:39], v[44:47], v[84:87]
    s_waitcnt lgkmcnt(6)
    v_mfma_f32_16x16x32_bf16 v[88:91], v[40:43], v[44:47], v[88:91]
    s_waitcnt lgkmcnt(0)
    s_barrier
    ds_read_b128 v[44:47], v2 offset:49152
    v_mfma_f32_16x16x32_bf16 v[92:95], v[28:31], v[48:51], v[92:95]
    ds_read_b64_tr_b16 v[12:13], v6 offset:49152
    v_mfma_f32_16x16x32_bf16 v[96:99], v[32:35], v[48:51], v[96:99]
    ds_read_b64_tr_b16 v[14:15], v6 offset:49664
    v_mfma_f32_16x16x32_bf16 v[100:103], v[36:39], v[48:51], v[100:103]
    ds_read_b64_tr_b16 v[16:17], v7 offset:49152
    v_mfma_f32_16x16x32_bf16 v[104:107], v[40:43], v[48:51], v[104:107]
    ds_read_b128 v[48:51], v2 offset:51200
    v_mfma_f32_16x16x32_bf16 v[108:111], v[28:31], v[52:55], v[108:111]
    ds_read_b64_tr_b16 v[18:19], v7 offset:49664
    v_mfma_f32_16x16x32_bf16 v[112:115], v[32:35], v[52:55], v[112:115]
    ds_read_b64_tr_b16 v[20:21], v6 offset:57344
    v_mfma_f32_16x16x32_bf16 v[116:119], v[36:39], v[52:55], v[116:119]
    ds_read_b64_tr_b16 v[22:23], v6 offset:57856
    v_mfma_f32_16x16x32_bf16 v[120:123], v[40:43], v[52:55], v[120:123]
    ds_read_b128 v[52:55], v2 offset:53248
    v_mfma_f32_16x16x32_bf16 v[124:127], v[28:31], v[56:59], v[124:127]
    ds_read_b64_tr_b16 v[24:25], v7 offset:57344
    v_mfma_f32_16x16x32_bf16 v[128:131], v[32:35], v[56:59], v[128:131]
    ds_read_b64_tr_b16 v[26:27], v7 offset:57856
    v_mfma_f32_16x16x32_bf16 v[132:135], v[36:39], v[56:59], v[132:135]
    v_mfma_f32_16x16x32_bf16 v[136:139], v[40:43], v[56:59], v[136:139]
    ds_read_b128 v[56:59], v2 offset:55296
    v_mfma_f32_16x16x32_bf16 v[140:143], v[28:31], v[60:63], v[140:143]
    v_mfma_f32_16x16x32_bf16 v[144:147], v[32:35], v[60:63], v[144:147]
    v_mfma_f32_16x16x32_bf16 v[148:151], v[36:39], v[60:63], v[148:151]
    ds_read_b64 v[250:251], v254 offset:8
    v_mfma_f32_16x16x32_bf16 v[152:155], v[40:43], v[60:63], v[152:155]
    ds_read_b128 v[60:63], v2 offset:57344
    v_mfma_f32_16x16x32_bf16 v[156:159], v[28:31], v[64:67], v[156:159]
    v_mfma_f32_16x16x32_bf16 v[160:163], v[32:35], v[64:67], v[160:163]
    v_mfma_f32_16x16x32_bf16 v[164:167], v[36:39], v[64:67], v[164:167]
    v_mfma_f32_16x16x32_bf16 v[168:171], v[40:43], v[64:67], v[168:171]
    ds_read_b128 v[64:67], v2 offset:59392
    v_mfma_f32_16x16x32_bf16 v[172:175], v[28:31], v[68:71], v[172:175]
    v_mfma_f32_16x16x32_bf16 v[176:179], v[32:35], v[68:71], v[176:179]
    v_mfma_f32_16x16x32_bf16 v[180:183], v[36:39], v[68:71], v[180:183]
    v_mfma_f32_16x16x32_bf16 v[184:187], v[40:43], v[68:71], v[184:187]
    ds_read_b128 v[68:71], v2 offset:61440
    v_mfma_f32_16x16x32_bf16 v[188:191], v[28:31], v[72:75], v[188:191]
    v_mfma_f32_16x16x32_bf16 v[192:195], v[32:35], v[72:75], v[192:195]
    v_mfma_f32_16x16x32_bf16 v[196:199], v[36:39], v[72:75], v[196:199]
    v_mfma_f32_16x16x32_bf16 v[200:203], v[40:43], v[72:75], v[200:203]
    ds_read_b128 v[72:75], v2 offset:63488
    s_waitcnt lgkmcnt(14)
    v_mfma_f32_16x16x32_bf16 v[76:79], v[12:15], v[44:47], v[76:79]
    ds_read_b64_tr_b16 v[28:29], v6 offset:53248
    s_waitcnt lgkmcnt(12)
    v_mfma_f32_16x16x32_bf16 v[80:83], v[16:19], v[44:47], v[80:83]
    ds_read_b64_tr_b16 v[30:31], v6 offset:53760
    s_waitcnt lgkmcnt(11)
    v_mfma_f32_16x16x32_bf16 v[84:87], v[20:23], v[44:47], v[84:87]
    ds_read_b64_tr_b16 v[32:33], v7 offset:53248
    s_waitcnt lgkmcnt(9)
    v_mfma_f32_16x16x32_bf16 v[88:91], v[24:27], v[44:47], v[88:91]
    ds_read_b128 v[44:47], v3 offset:49152
    v_mfma_f32_16x16x32_bf16 v[92:95], v[12:15], v[48:51], v[92:95]
    ds_read_b64_tr_b16 v[34:35], v7 offset:53760
    v_mfma_f32_16x16x32_bf16 v[96:99], v[16:19], v[48:51], v[96:99]
    ds_read_b64_tr_b16 v[36:37], v6 offset:61440
    v_mfma_f32_16x16x32_bf16 v[100:103], v[20:23], v[48:51], v[100:103]
    ds_read_b64_tr_b16 v[38:39], v6 offset:61952
    v_mfma_f32_16x16x32_bf16 v[104:107], v[24:27], v[48:51], v[104:107]
    ds_read_b128 v[48:51], v3 offset:51200
    v_mfma_f32_16x16x32_bf16 v[108:111], v[12:15], v[52:55], v[108:111]
    ds_read_b64_tr_b16 v[40:41], v7 offset:61440
    v_mfma_f32_16x16x32_bf16 v[112:115], v[16:19], v[52:55], v[112:115]
    ds_read_b64_tr_b16 v[42:43], v7 offset:61952
    v_mfma_f32_16x16x32_bf16 v[116:119], v[20:23], v[52:55], v[116:119]
    v_mfma_f32_16x16x32_bf16 v[120:123], v[24:27], v[52:55], v[120:123]
    ds_read_b128 v[52:55], v3 offset:53248
    s_waitcnt lgkmcnt(14)
    v_mfma_f32_16x16x32_bf16 v[124:127], v[12:15], v[56:59], v[124:127]
    v_mfma_f32_16x16x32_bf16 v[128:131], v[16:19], v[56:59], v[128:131]
    v_mfma_f32_16x16x32_bf16 v[132:135], v[20:23], v[56:59], v[132:135]
    v_mfma_f32_16x16x32_bf16 v[136:139], v[24:27], v[56:59], v[136:139]
    ds_read_b128 v[56:59], v3 offset:55296
    s_waitcnt lgkmcnt(14)
    v_mfma_f32_16x16x32_bf16 v[140:143], v[12:15], v[60:63], v[140:143]
    v_mfma_f32_16x16x32_bf16 v[144:147], v[16:19], v[60:63], v[144:147]
    v_mfma_f32_16x16x32_bf16 v[148:151], v[20:23], v[60:63], v[148:151]
    v_readfirstlane_b32 s0, v250
    v_readfirstlane_b32 s1, v251
    v_mfma_f32_16x16x32_bf16 v[152:155], v[24:27], v[60:63], v[152:155]
    ds_read_b128 v[60:63], v3 offset:57344
    s_waitcnt lgkmcnt(14)
    v_mfma_f32_16x16x32_bf16 v[156:159], v[12:15], v[64:67], v[156:159]
    v_mfma_f32_16x16x32_bf16 v[160:163], v[16:19], v[64:67], v[160:163]
    v_mfma_f32_16x16x32_bf16 v[164:167], v[20:23], v[64:67], v[164:167]
    v_mfma_f32_16x16x32_bf16 v[168:171], v[24:27], v[64:67], v[168:171]
    ds_read_b128 v[64:67], v3 offset:59392
    s_waitcnt lgkmcnt(14)
    v_mfma_f32_16x16x32_bf16 v[172:175], v[12:15], v[68:71], v[172:175]
    v_mfma_f32_16x16x32_bf16 v[176:179], v[16:19], v[68:71], v[176:179]
    v_mfma_f32_16x16x32_bf16 v[180:183], v[20:23], v[68:71], v[180:183]
    v_mfma_f32_16x16x32_bf16 v[184:187], v[24:27], v[68:71], v[184:187]
    ds_read_b128 v[68:71], v3 offset:61440
    s_waitcnt lgkmcnt(14)
    v_mfma_f32_16x16x32_bf16 v[188:191], v[12:15], v[72:75], v[188:191]
    v_mfma_f32_16x16x32_bf16 v[192:195], v[16:19], v[72:75], v[192:195]
    v_mfma_f32_16x16x32_bf16 v[196:199], v[20:23], v[72:75], v[196:199]
    v_mfma_f32_16x16x32_bf16 v[200:203], v[24:27], v[72:75], v[200:203]
    ds_read_b128 v[72:75], v3 offset:63488
    s_waitcnt lgkmcnt(12)
    v_mfma_f32_16x16x32_bf16 v[76:79], v[28:31], v[44:47], v[76:79]
    s_waitcnt lgkmcnt(11)
    v_mfma_f32_16x16x32_bf16 v[80:83], v[32:35], v[44:47], v[80:83]
    s_waitcnt lgkmcnt(9)
    v_mfma_f32_16x16x32_bf16 v[84:87], v[36:39], v[44:47], v[84:87]
    s_waitcnt lgkmcnt(6)
    v_mfma_f32_16x16x32_bf16 v[88:91], v[40:43], v[44:47], v[88:91]
    s_waitcnt lgkmcnt(0)
    s_barrier
    ds_read_b128 v[44:47], v2 offset:0
    v_mfma_f32_16x16x32_bf16 v[92:95], v[28:31], v[48:51], v[92:95]
    ds_read_b64_tr_b16 v[12:13], v6 offset:0
    v_mfma_f32_16x16x32_bf16 v[96:99], v[32:35], v[48:51], v[96:99]
    ds_read_b64_tr_b16 v[14:15], v6 offset:512
    v_mfma_f32_16x16x32_bf16 v[100:103], v[36:39], v[48:51], v[100:103]
    ds_read_b64_tr_b16 v[16:17], v7 offset:0
    v_mfma_f32_16x16x32_bf16 v[104:107], v[40:43], v[48:51], v[104:107]
    ds_read_b128 v[48:51], v2 offset:2048
    v_mfma_f32_16x16x32_bf16 v[108:111], v[28:31], v[52:55], v[108:111]
    ds_read_b64_tr_b16 v[18:19], v7 offset:512
    v_mfma_f32_16x16x32_bf16 v[112:115], v[32:35], v[52:55], v[112:115]
    ds_read_b64_tr_b16 v[20:21], v6 offset:8192
    v_mfma_f32_16x16x32_bf16 v[116:119], v[36:39], v[52:55], v[116:119]
    ds_read_b64_tr_b16 v[22:23], v6 offset:8704
    v_mfma_f32_16x16x32_bf16 v[120:123], v[40:43], v[52:55], v[120:123]
    ds_read_b128 v[52:55], v2 offset:4096
    v_mfma_f32_16x16x32_bf16 v[124:127], v[28:31], v[56:59], v[124:127]
    ds_read_b64_tr_b16 v[24:25], v7 offset:8192
    v_mfma_f32_16x16x32_bf16 v[128:131], v[32:35], v[56:59], v[128:131]
    ds_read_b64_tr_b16 v[26:27], v7 offset:8704
    v_mfma_f32_16x16x32_bf16 v[132:135], v[36:39], v[56:59], v[132:135]
    v_mfma_f32_16x16x32_bf16 v[136:139], v[40:43], v[56:59], v[136:139]
    ds_read_b128 v[56:59], v2 offset:6144
    v_mfma_f32_16x16x32_bf16 v[140:143], v[28:31], v[60:63], v[140:143]
    v_mfma_f32_16x16x32_bf16 v[144:147], v[32:35], v[60:63], v[144:147]
    v_mfma_f32_16x16x32_bf16 v[148:151], v[36:39], v[60:63], v[148:151]
    v_mfma_f32_16x16x32_bf16 v[152:155], v[40:43], v[60:63], v[152:155]
    ds_read_b128 v[60:63], v2 offset:8192
    v_mfma_f32_16x16x32_bf16 v[156:159], v[28:31], v[64:67], v[156:159]
    v_mfma_f32_16x16x32_bf16 v[160:163], v[32:35], v[64:67], v[160:163]
    v_mfma_f32_16x16x32_bf16 v[164:167], v[36:39], v[64:67], v[164:167]
    v_mfma_f32_16x16x32_bf16 v[168:171], v[40:43], v[64:67], v[168:171]
    ds_read_b128 v[64:67], v2 offset:10240
    v_mfma_f32_16x16x32_bf16 v[172:175], v[28:31], v[68:71], v[172:175]
    v_mfma_f32_16x16x32_bf16 v[176:179], v[32:35], v[68:71], v[176:179]
    v_mfma_f32_16x16x32_bf16 v[180:183], v[36:39], v[68:71], v[180:183]
    v_mfma_f32_16x16x32_bf16 v[184:187], v[40:43], v[68:71], v[184:187]
    ds_read_b128 v[68:71], v2 offset:12288
    v_mfma_f32_16x16x32_bf16 v[188:191], v[28:31], v[72:75], v[188:191]
    v_mfma_f32_16x16x32_bf16 v[192:195], v[32:35], v[72:75], v[192:195]
    v_mfma_f32_16x16x32_bf16 v[196:199], v[36:39], v[72:75], v[196:199]
    v_mfma_f32_16x16x32_bf16 v[200:203], v[40:43], v[72:75], v[200:203]
    ds_read_b128 v[72:75], v2 offset:14336
    s_waitcnt lgkmcnt(13)
    v_mfma_f32_16x16x32_bf16 v[76:79], v[12:15], v[44:47], v[76:79]
    ds_read_b64_tr_b16 v[28:29], v6 offset:4096
    s_waitcnt lgkmcnt(11)
    v_mfma_f32_16x16x32_bf16 v[80:83], v[16:19], v[44:47], v[80:83]
    ds_read_b64_tr_b16 v[30:31], v6 offset:4608
    s_waitcnt lgkmcnt(10)
    v_mfma_f32_16x16x32_bf16 v[84:87], v[20:23], v[44:47], v[84:87]
    ds_read_b64_tr_b16 v[32:33], v7 offset:4096
    s_waitcnt lgkmcnt(8)
    v_mfma_f32_16x16x32_bf16 v[88:91], v[24:27], v[44:47], v[88:91]
    ds_read_b128 v[44:47], v3 offset:0
    v_mfma_f32_16x16x32_bf16 v[92:95], v[12:15], v[48:51], v[92:95]
    ds_read_b64_tr_b16 v[34:35], v7 offset:4608
    v_mfma_f32_16x16x32_bf16 v[96:99], v[16:19], v[48:51], v[96:99]
    ds_read_b64_tr_b16 v[36:37], v6 offset:12288
    v_mfma_f32_16x16x32_bf16 v[100:103], v[20:23], v[48:51], v[100:103]
    ds_read_b64_tr_b16 v[38:39], v6 offset:12800
    v_mfma_f32_16x16x32_bf16 v[104:107], v[24:27], v[48:51], v[104:107]
    ds_read_b128 v[48:51], v3 offset:2048
    v_mfma_f32_16x16x32_bf16 v[108:111], v[12:15], v[52:55], v[108:111]
    ds_read_b64_tr_b16 v[40:41], v7 offset:12288
    v_mfma_f32_16x16x32_bf16 v[112:115], v[16:19], v[52:55], v[112:115]
    ds_read_b64_tr_b16 v[42:43], v7 offset:12800
    v_mfma_f32_16x16x32_bf16 v[116:119], v[20:23], v[52:55], v[116:119]
    v_mfma_f32_16x16x32_bf16 v[120:123], v[24:27], v[52:55], v[120:123]
    ds_read_b128 v[52:55], v3 offset:4096
    s_waitcnt lgkmcnt(14)
    v_mfma_f32_16x16x32_bf16 v[124:127], v[12:15], v[56:59], v[124:127]
    v_mfma_f32_16x16x32_bf16 v[128:131], v[16:19], v[56:59], v[128:131]
    v_mfma_f32_16x16x32_bf16 v[132:135], v[20:23], v[56:59], v[132:135]
    v_mfma_f32_16x16x32_bf16 v[136:139], v[24:27], v[56:59], v[136:139]
    ds_read_b128 v[56:59], v3 offset:6144
    s_waitcnt lgkmcnt(14)
    v_mfma_f32_16x16x32_bf16 v[140:143], v[12:15], v[60:63], v[140:143]
    v_mfma_f32_16x16x32_bf16 v[144:147], v[16:19], v[60:63], v[144:147]
    v_mfma_f32_16x16x32_bf16 v[148:151], v[20:23], v[60:63], v[148:151]
    v_mfma_f32_16x16x32_bf16 v[152:155], v[24:27], v[60:63], v[152:155]
    ds_read_b128 v[60:63], v3 offset:8192
    s_waitcnt lgkmcnt(14)
    v_mfma_f32_16x16x32_bf16 v[156:159], v[12:15], v[64:67], v[156:159]
    v_mfma_f32_16x16x32_bf16 v[160:163], v[16:19], v[64:67], v[160:163]
    v_mfma_f32_16x16x32_bf16 v[164:167], v[20:23], v[64:67], v[164:167]
    v_mfma_f32_16x16x32_bf16 v[168:171], v[24:27], v[64:67], v[168:171]
    ds_read_b128 v[64:67], v3 offset:10240
    s_waitcnt lgkmcnt(14)
    v_mfma_f32_16x16x32_bf16 v[172:175], v[12:15], v[68:71], v[172:175]
    v_mfma_f32_16x16x32_bf16 v[176:179], v[16:19], v[68:71], v[176:179]
    v_mfma_f32_16x16x32_bf16 v[180:183], v[20:23], v[68:71], v[180:183]
    v_mfma_f32_16x16x32_bf16 v[184:187], v[24:27], v[68:71], v[184:187]
    ds_read_b128 v[68:71], v3 offset:12288
    s_waitcnt lgkmcnt(14)
    v_mfma_f32_16x16x32_bf16 v[188:191], v[12:15], v[72:75], v[188:191]
    v_mfma_f32_16x16x32_bf16 v[192:195], v[16:19], v[72:75], v[192:195]
    v_mfma_f32_16x16x32_bf16 v[196:199], v[20:23], v[72:75], v[196:199]
    v_mfma_f32_16x16x32_bf16 v[200:203], v[24:27], v[72:75], v[200:203]
    ds_read_b128 v[72:75], v3 offset:14336
    s_waitcnt lgkmcnt(12)
    v_mfma_f32_16x16x32_bf16 v[76:79], v[28:31], v[44:47], v[76:79]
    s_waitcnt lgkmcnt(11)
    v_mfma_f32_16x16x32_bf16 v[80:83], v[32:35], v[44:47], v[80:83]
    s_waitcnt lgkmcnt(9)
    v_mfma_f32_16x16x32_bf16 v[84:87], v[36:39], v[44:47], v[84:87]
    s_waitcnt lgkmcnt(6)
    v_mfma_f32_16x16x32_bf16 v[88:91], v[40:43], v[44:47], v[88:91]
    s_waitcnt lgkmcnt(0)
    s_barrier
    ds_read_b128 v[44:47], v4 offset:0
    v_mfma_f32_16x16x32_bf16 v[92:95], v[28:31], v[48:51], v[92:95]
    ds_read_b64_tr_b16 v[12:13], v8 offset:0
    v_mfma_f32_16x16x32_bf16 v[96:99], v[32:35], v[48:51], v[96:99]
    ds_read_b64_tr_b16 v[14:15], v8 offset:512
    v_mfma_f32_16x16x32_bf16 v[100:103], v[36:39], v[48:51], v[100:103]
    ds_read_b64_tr_b16 v[16:17], v9 offset:0
    v_mfma_f32_16x16x32_bf16 v[104:107], v[40:43], v[48:51], v[104:107]
    ds_read_b128 v[48:51], v4 offset:2048
    v_mfma_f32_16x16x32_bf16 v[108:111], v[28:31], v[52:55], v[108:111]
    ds_read_b64_tr_b16 v[18:19], v9 offset:512
    v_mfma_f32_16x16x32_bf16 v[112:115], v[32:35], v[52:55], v[112:115]
    ds_read_b64_tr_b16 v[20:21], v8 offset:8192
    v_mfma_f32_16x16x32_bf16 v[116:119], v[36:39], v[52:55], v[116:119]
    ds_read_b64_tr_b16 v[22:23], v8 offset:8704
    v_mfma_f32_16x16x32_bf16 v[120:123], v[40:43], v[52:55], v[120:123]
    ds_read_b128 v[52:55], v4 offset:4096
    v_mfma_f32_16x16x32_bf16 v[124:127], v[28:31], v[56:59], v[124:127]
    ds_read_b64_tr_b16 v[24:25], v9 offset:8192
    v_mfma_f32_16x16x32_bf16 v[128:131], v[32:35], v[56:59], v[128:131]
    ds_read_b64_tr_b16 v[26:27], v9 offset:8704
    v_mfma_f32_16x16x32_bf16 v[132:135], v[36:39], v[56:59], v[132:135]
    v_mfma_f32_16x16x32_bf16 v[136:139], v[40:43], v[56:59], v[136:139]
    ds_read_b128 v[56:59], v4 offset:6144
    v_mfma_f32_16x16x32_bf16 v[140:143], v[28:31], v[60:63], v[140:143]
    v_mfma_f32_16x16x32_bf16 v[144:147], v[32:35], v[60:63], v[144:147]
    v_mfma_f32_16x16x32_bf16 v[148:151], v[36:39], v[60:63], v[148:151]
    v_mfma_f32_16x16x32_bf16 v[152:155], v[40:43], v[60:63], v[152:155]
    ds_read_b128 v[60:63], v4 offset:8192
    v_mfma_f32_16x16x32_bf16 v[156:159], v[28:31], v[64:67], v[156:159]
    v_mfma_f32_16x16x32_bf16 v[160:163], v[32:35], v[64:67], v[160:163]
    v_mfma_f32_16x16x32_bf16 v[164:167], v[36:39], v[64:67], v[164:167]
    v_mfma_f32_16x16x32_bf16 v[168:171], v[40:43], v[64:67], v[168:171]
    ds_read_b128 v[64:67], v4 offset:10240
    v_mfma_f32_16x16x32_bf16 v[172:175], v[28:31], v[68:71], v[172:175]
    v_mfma_f32_16x16x32_bf16 v[176:179], v[32:35], v[68:71], v[176:179]
    v_mfma_f32_16x16x32_bf16 v[180:183], v[36:39], v[68:71], v[180:183]
    v_mfma_f32_16x16x32_bf16 v[184:187], v[40:43], v[68:71], v[184:187]
    ds_read_b128 v[68:71], v4 offset:12288
    v_mfma_f32_16x16x32_bf16 v[188:191], v[28:31], v[72:75], v[188:191]
    v_mfma_f32_16x16x32_bf16 v[192:195], v[32:35], v[72:75], v[192:195]
    v_mfma_f32_16x16x32_bf16 v[196:199], v[36:39], v[72:75], v[196:199]
    v_mfma_f32_16x16x32_bf16 v[200:203], v[40:43], v[72:75], v[200:203]
    ds_read_b128 v[72:75], v4 offset:14336
    s_waitcnt lgkmcnt(13)
    v_mfma_f32_16x16x32_bf16 v[76:79], v[12:15], v[44:47], v[76:79]
    ds_read_b64_tr_b16 v[28:29], v8 offset:4096
    s_waitcnt lgkmcnt(11)
    v_mfma_f32_16x16x32_bf16 v[80:83], v[16:19], v[44:47], v[80:83]
    ds_read_b64_tr_b16 v[30:31], v8 offset:4608
    s_waitcnt lgkmcnt(10)
    v_mfma_f32_16x16x32_bf16 v[84:87], v[20:23], v[44:47], v[84:87]
    ds_read_b64_tr_b16 v[32:33], v9 offset:4096
    s_waitcnt lgkmcnt(8)
    v_mfma_f32_16x16x32_bf16 v[88:91], v[24:27], v[44:47], v[88:91]
    ds_read_b128 v[44:47], v5 offset:0
    v_mfma_f32_16x16x32_bf16 v[92:95], v[12:15], v[48:51], v[92:95]
    ds_read_b64_tr_b16 v[34:35], v9 offset:4608
    v_mfma_f32_16x16x32_bf16 v[96:99], v[16:19], v[48:51], v[96:99]
    ds_read_b64_tr_b16 v[36:37], v8 offset:12288
    v_mfma_f32_16x16x32_bf16 v[100:103], v[20:23], v[48:51], v[100:103]
    ds_read_b64_tr_b16 v[38:39], v8 offset:12800
    v_mfma_f32_16x16x32_bf16 v[104:107], v[24:27], v[48:51], v[104:107]
    ds_read_b128 v[48:51], v5 offset:2048
    v_mfma_f32_16x16x32_bf16 v[108:111], v[12:15], v[52:55], v[108:111]
    ds_read_b64_tr_b16 v[40:41], v9 offset:12288
    v_mfma_f32_16x16x32_bf16 v[112:115], v[16:19], v[52:55], v[112:115]
    ds_read_b64_tr_b16 v[42:43], v9 offset:12800
    v_mfma_f32_16x16x32_bf16 v[116:119], v[20:23], v[52:55], v[116:119]
    v_mfma_f32_16x16x32_bf16 v[120:123], v[24:27], v[52:55], v[120:123]
    ds_read_b128 v[52:55], v5 offset:4096
    s_waitcnt lgkmcnt(14)
    v_mfma_f32_16x16x32_bf16 v[124:127], v[12:15], v[56:59], v[124:127]
    v_mfma_f32_16x16x32_bf16 v[128:131], v[16:19], v[56:59], v[128:131]
    v_mfma_f32_16x16x32_bf16 v[132:135], v[20:23], v[56:59], v[132:135]
    v_mfma_f32_16x16x32_bf16 v[136:139], v[24:27], v[56:59], v[136:139]
    ds_read_b128 v[56:59], v5 offset:6144
    s_waitcnt lgkmcnt(14)
    v_mfma_f32_16x16x32_bf16 v[140:143], v[12:15], v[60:63], v[140:143]
    v_mfma_f32_16x16x32_bf16 v[144:147], v[16:19], v[60:63], v[144:147]
    v_mfma_f32_16x16x32_bf16 v[148:151], v[20:23], v[60:63], v[148:151]
    v_mfma_f32_16x16x32_bf16 v[152:155], v[24:27], v[60:63], v[152:155]
    ds_read_b128 v[60:63], v5 offset:8192
    s_waitcnt lgkmcnt(14)
    v_mfma_f32_16x16x32_bf16 v[156:159], v[12:15], v[64:67], v[156:159]
    v_mfma_f32_16x16x32_bf16 v[160:163], v[16:19], v[64:67], v[160:163]
    v_mfma_f32_16x16x32_bf16 v[164:167], v[20:23], v[64:67], v[164:167]
    v_mfma_f32_16x16x32_bf16 v[168:171], v[24:27], v[64:67], v[168:171]
    ds_read_b128 v[64:67], v5 offset:10240
    s_waitcnt lgkmcnt(14)
    v_mfma_f32_16x16x32_bf16 v[172:175], v[12:15], v[68:71], v[172:175]
    v_mfma_f32_16x16x32_bf16 v[176:179], v[16:19], v[68:71], v[176:179]
    v_mfma_f32_16x16x32_bf16 v[180:183], v[20:23], v[68:71], v[180:183]
    v_mfma_f32_16x16x32_bf16 v[184:187], v[24:27], v[68:71], v[184:187]
    ds_read_b128 v[68:71], v5 offset:12288
    s_waitcnt lgkmcnt(14)
    v_mfma_f32_16x16x32_bf16 v[188:191], v[12:15], v[72:75], v[188:191]
    v_mfma_f32_16x16x32_bf16 v[192:195], v[16:19], v[72:75], v[192:195]
    v_mfma_f32_16x16x32_bf16 v[196:199], v[20:23], v[72:75], v[196:199]
    v_mfma_f32_16x16x32_bf16 v[200:203], v[24:27], v[72:75], v[200:203]
    ds_read_b128 v[72:75], v5 offset:14336
    s_waitcnt lgkmcnt(12)
    v_mfma_f32_16x16x32_bf16 v[76:79], v[28:31], v[44:47], v[76:79]
    s_waitcnt lgkmcnt(11)
    v_mfma_f32_16x16x32_bf16 v[80:83], v[32:35], v[44:47], v[80:83]
    s_waitcnt lgkmcnt(9)
    v_mfma_f32_16x16x32_bf16 v[84:87], v[36:39], v[44:47], v[84:87]
    s_waitcnt lgkmcnt(6)
    v_mfma_f32_16x16x32_bf16 v[88:91], v[40:43], v[44:47], v[88:91]
    s_waitcnt lgkmcnt(0)
    s_barrier
    ds_read_b128 v[44:47], v2 offset:49152
    v_mfma_f32_16x16x32_bf16 v[92:95], v[28:31], v[48:51], v[92:95]
    ds_read_b64_tr_b16 v[12:13], v6 offset:49152
    v_mfma_f32_16x16x32_bf16 v[96:99], v[32:35], v[48:51], v[96:99]
    ds_read_b64_tr_b16 v[14:15], v6 offset:49664
    v_mfma_f32_16x16x32_bf16 v[100:103], v[36:39], v[48:51], v[100:103]
    ds_read_b64_tr_b16 v[16:17], v7 offset:49152
    v_mfma_f32_16x16x32_bf16 v[104:107], v[40:43], v[48:51], v[104:107]
    ds_read_b128 v[48:51], v2 offset:51200
    v_mfma_f32_16x16x32_bf16 v[108:111], v[28:31], v[52:55], v[108:111]
    ds_read_b64_tr_b16 v[18:19], v7 offset:49664
    v_mfma_f32_16x16x32_bf16 v[112:115], v[32:35], v[52:55], v[112:115]
    ds_read_b64_tr_b16 v[20:21], v6 offset:57344
    v_mfma_f32_16x16x32_bf16 v[116:119], v[36:39], v[52:55], v[116:119]
    ds_read_b64_tr_b16 v[22:23], v6 offset:57856
    v_mfma_f32_16x16x32_bf16 v[120:123], v[40:43], v[52:55], v[120:123]
    ds_read_b128 v[52:55], v2 offset:53248
    v_mfma_f32_16x16x32_bf16 v[124:127], v[28:31], v[56:59], v[124:127]
    ds_read_b64_tr_b16 v[24:25], v7 offset:57344
    v_mfma_f32_16x16x32_bf16 v[128:131], v[32:35], v[56:59], v[128:131]
    ds_read_b64_tr_b16 v[26:27], v7 offset:57856
    v_mfma_f32_16x16x32_bf16 v[132:135], v[36:39], v[56:59], v[132:135]
    v_mfma_f32_16x16x32_bf16 v[136:139], v[40:43], v[56:59], v[136:139]
    ds_read_b128 v[56:59], v2 offset:55296
    v_mfma_f32_16x16x32_bf16 v[140:143], v[28:31], v[60:63], v[140:143]
    v_mfma_f32_16x16x32_bf16 v[144:147], v[32:35], v[60:63], v[144:147]
    v_mfma_f32_16x16x32_bf16 v[148:151], v[36:39], v[60:63], v[148:151]
    v_mfma_f32_16x16x32_bf16 v[152:155], v[40:43], v[60:63], v[152:155]
    ds_read_b128 v[60:63], v2 offset:57344
    v_mfma_f32_16x16x32_bf16 v[156:159], v[28:31], v[64:67], v[156:159]
    v_mfma_f32_16x16x32_bf16 v[160:163], v[32:35], v[64:67], v[160:163]
    v_mfma_f32_16x16x32_bf16 v[164:167], v[36:39], v[64:67], v[164:167]
    v_mfma_f32_16x16x32_bf16 v[168:171], v[40:43], v[64:67], v[168:171]
    ds_read_b128 v[64:67], v2 offset:59392
    v_mfma_f32_16x16x32_bf16 v[172:175], v[28:31], v[68:71], v[172:175]
    v_mfma_f32_16x16x32_bf16 v[176:179], v[32:35], v[68:71], v[176:179]
    v_mfma_f32_16x16x32_bf16 v[180:183], v[36:39], v[68:71], v[180:183]
    v_mfma_f32_16x16x32_bf16 v[184:187], v[40:43], v[68:71], v[184:187]
    ds_read_b128 v[68:71], v2 offset:61440
    v_mfma_f32_16x16x32_bf16 v[188:191], v[28:31], v[72:75], v[188:191]
    v_mfma_f32_16x16x32_bf16 v[192:195], v[32:35], v[72:75], v[192:195]
    v_mfma_f32_16x16x32_bf16 v[196:199], v[36:39], v[72:75], v[196:199]
    v_mfma_f32_16x16x32_bf16 v[200:203], v[40:43], v[72:75], v[200:203]
    ds_read_b128 v[72:75], v2 offset:63488
    s_waitcnt lgkmcnt(13)
    v_mfma_f32_16x16x32_bf16 v[76:79], v[12:15], v[44:47], v[76:79]
    ds_read_b64_tr_b16 v[28:29], v6 offset:53248
    s_waitcnt lgkmcnt(11)
    v_mfma_f32_16x16x32_bf16 v[80:83], v[16:19], v[44:47], v[80:83]
    ds_read_b64_tr_b16 v[30:31], v6 offset:53760
    s_waitcnt lgkmcnt(10)
    v_mfma_f32_16x16x32_bf16 v[84:87], v[20:23], v[44:47], v[84:87]
    ds_read_b64_tr_b16 v[32:33], v7 offset:53248
    s_waitcnt lgkmcnt(8)
    v_mfma_f32_16x16x32_bf16 v[88:91], v[24:27], v[44:47], v[88:91]
    ds_read_b128 v[44:47], v3 offset:49152
    v_mfma_f32_16x16x32_bf16 v[92:95], v[12:15], v[48:51], v[92:95]
    ds_read_b64_tr_b16 v[34:35], v7 offset:53760
    v_mfma_f32_16x16x32_bf16 v[96:99], v[16:19], v[48:51], v[96:99]
    ds_read_b64_tr_b16 v[36:37], v6 offset:61440
    v_mfma_f32_16x16x32_bf16 v[100:103], v[20:23], v[48:51], v[100:103]
    ds_read_b64_tr_b16 v[38:39], v6 offset:61952
    v_mfma_f32_16x16x32_bf16 v[104:107], v[24:27], v[48:51], v[104:107]
    ds_read_b128 v[48:51], v3 offset:51200
    v_mfma_f32_16x16x32_bf16 v[108:111], v[12:15], v[52:55], v[108:111]
    ds_read_b64_tr_b16 v[40:41], v7 offset:61440
    v_mfma_f32_16x16x32_bf16 v[112:115], v[16:19], v[52:55], v[112:115]
    ds_read_b64_tr_b16 v[42:43], v7 offset:61952
    v_mfma_f32_16x16x32_bf16 v[116:119], v[20:23], v[52:55], v[116:119]
    v_mfma_f32_16x16x32_bf16 v[120:123], v[24:27], v[52:55], v[120:123]
    ds_read_b128 v[52:55], v3 offset:53248
    s_waitcnt lgkmcnt(14)
    v_mfma_f32_16x16x32_bf16 v[124:127], v[12:15], v[56:59], v[124:127]
    v_mfma_f32_16x16x32_bf16 v[128:131], v[16:19], v[56:59], v[128:131]
    v_mfma_f32_16x16x32_bf16 v[132:135], v[20:23], v[56:59], v[132:135]
    v_mfma_f32_16x16x32_bf16 v[136:139], v[24:27], v[56:59], v[136:139]
    ds_read_b128 v[56:59], v3 offset:55296
    s_waitcnt lgkmcnt(14)
    v_mfma_f32_16x16x32_bf16 v[140:143], v[12:15], v[60:63], v[140:143]
    v_mfma_f32_16x16x32_bf16 v[144:147], v[16:19], v[60:63], v[144:147]
    v_mfma_f32_16x16x32_bf16 v[148:151], v[20:23], v[60:63], v[148:151]
    v_mfma_f32_16x16x32_bf16 v[152:155], v[24:27], v[60:63], v[152:155]
    ds_read_b128 v[60:63], v3 offset:57344
    s_waitcnt lgkmcnt(14)
    v_mfma_f32_16x16x32_bf16 v[156:159], v[12:15], v[64:67], v[156:159]
    v_mfma_f32_16x16x32_bf16 v[160:163], v[16:19], v[64:67], v[160:163]
    v_mfma_f32_16x16x32_bf16 v[164:167], v[20:23], v[64:67], v[164:167]
    v_mfma_f32_16x16x32_bf16 v[168:171], v[24:27], v[64:67], v[168:171]
    ds_read_b128 v[64:67], v3 offset:59392
    s_waitcnt lgkmcnt(14)
    v_mfma_f32_16x16x32_bf16 v[172:175], v[12:15], v[68:71], v[172:175]
    v_mfma_f32_16x16x32_bf16 v[176:179], v[16:19], v[68:71], v[176:179]
    v_mfma_f32_16x16x32_bf16 v[180:183], v[20:23], v[68:71], v[180:183]
    v_mfma_f32_16x16x32_bf16 v[184:187], v[24:27], v[68:71], v[184:187]
    ds_read_b128 v[68:71], v3 offset:61440
    s_waitcnt lgkmcnt(14)
    v_mfma_f32_16x16x32_bf16 v[188:191], v[12:15], v[72:75], v[188:191]
    v_mfma_f32_16x16x32_bf16 v[192:195], v[16:19], v[72:75], v[192:195]
    v_mfma_f32_16x16x32_bf16 v[196:199], v[20:23], v[72:75], v[196:199]
    v_mfma_f32_16x16x32_bf16 v[200:203], v[24:27], v[72:75], v[200:203]
    ds_read_b128 v[72:75], v3 offset:63488
    s_waitcnt lgkmcnt(12)
    v_mfma_f32_16x16x32_bf16 v[76:79], v[28:31], v[44:47], v[76:79]
    s_waitcnt lgkmcnt(11)
    v_mfma_f32_16x16x32_bf16 v[80:83], v[32:35], v[44:47], v[80:83]
    s_waitcnt lgkmcnt(9)
    v_mfma_f32_16x16x32_bf16 v[84:87], v[36:39], v[44:47], v[84:87]
    s_waitcnt lgkmcnt(6)
    v_mfma_f32_16x16x32_bf16 v[88:91], v[40:43], v[44:47], v[88:91]
    s_waitcnt lgkmcnt(0)
    s_barrier
    ds_read_b128 v[44:47], v2 offset:0
    v_mfma_f32_16x16x32_bf16 v[92:95], v[28:31], v[48:51], v[92:95]
    ds_read_b64_tr_b16 v[12:13], v6 offset:0
    v_mfma_f32_16x16x32_bf16 v[96:99], v[32:35], v[48:51], v[96:99]
    ds_read_b64_tr_b16 v[14:15], v6 offset:512
    v_mfma_f32_16x16x32_bf16 v[100:103], v[36:39], v[48:51], v[100:103]
    ds_read_b64_tr_b16 v[16:17], v7 offset:0
    v_mfma_f32_16x16x32_bf16 v[104:107], v[40:43], v[48:51], v[104:107]
    ds_read_b128 v[48:51], v2 offset:2048
    v_mfma_f32_16x16x32_bf16 v[108:111], v[28:31], v[52:55], v[108:111]
    ds_read_b64_tr_b16 v[18:19], v7 offset:512
    v_mfma_f32_16x16x32_bf16 v[112:115], v[32:35], v[52:55], v[112:115]
    ds_read_b64_tr_b16 v[20:21], v6 offset:8192
    v_mfma_f32_16x16x32_bf16 v[116:119], v[36:39], v[52:55], v[116:119]
    ds_read_b64_tr_b16 v[22:23], v6 offset:8704
    v_mfma_f32_16x16x32_bf16 v[120:123], v[40:43], v[52:55], v[120:123]
    ds_read_b128 v[52:55], v2 offset:4096
    v_mfma_f32_16x16x32_bf16 v[124:127], v[28:31], v[56:59], v[124:127]
    ds_read_b64_tr_b16 v[24:25], v7 offset:8192
    v_mfma_f32_16x16x32_bf16 v[128:131], v[32:35], v[56:59], v[128:131]
    ds_read_b64_tr_b16 v[26:27], v7 offset:8704
    v_mfma_f32_16x16x32_bf16 v[132:135], v[36:39], v[56:59], v[132:135]
    v_mfma_f32_16x16x32_bf16 v[136:139], v[40:43], v[56:59], v[136:139]
    ds_read_b128 v[56:59], v2 offset:6144
    v_mfma_f32_16x16x32_bf16 v[140:143], v[28:31], v[60:63], v[140:143]
    v_mfma_f32_16x16x32_bf16 v[144:147], v[32:35], v[60:63], v[144:147]
    v_mfma_f32_16x16x32_bf16 v[148:151], v[36:39], v[60:63], v[148:151]
    v_mfma_f32_16x16x32_bf16 v[152:155], v[40:43], v[60:63], v[152:155]
    ds_read_b128 v[60:63], v2 offset:8192
    v_mfma_f32_16x16x32_bf16 v[156:159], v[28:31], v[64:67], v[156:159]
    v_mfma_f32_16x16x32_bf16 v[160:163], v[32:35], v[64:67], v[160:163]
    v_mfma_f32_16x16x32_bf16 v[164:167], v[36:39], v[64:67], v[164:167]
    v_mfma_f32_16x16x32_bf16 v[168:171], v[40:43], v[64:67], v[168:171]
    ds_read_b128 v[64:67], v2 offset:10240
    v_mfma_f32_16x16x32_bf16 v[172:175], v[28:31], v[68:71], v[172:175]
    v_mfma_f32_16x16x32_bf16 v[176:179], v[32:35], v[68:71], v[176:179]
    v_mfma_f32_16x16x32_bf16 v[180:183], v[36:39], v[68:71], v[180:183]
    v_mfma_f32_16x16x32_bf16 v[184:187], v[40:43], v[68:71], v[184:187]
    ds_read_b128 v[68:71], v2 offset:12288
    v_mfma_f32_16x16x32_bf16 v[188:191], v[28:31], v[72:75], v[188:191]
    v_mfma_f32_16x16x32_bf16 v[192:195], v[32:35], v[72:75], v[192:195]
    v_mfma_f32_16x16x32_bf16 v[196:199], v[36:39], v[72:75], v[196:199]
    v_mfma_f32_16x16x32_bf16 v[200:203], v[40:43], v[72:75], v[200:203]
    ds_read_b128 v[72:75], v2 offset:14336
    s_waitcnt lgkmcnt(13)
    v_mfma_f32_16x16x32_bf16 v[76:79], v[12:15], v[44:47], v[76:79]
    ds_read_b64_tr_b16 v[28:29], v6 offset:4096
    s_waitcnt lgkmcnt(11)
    v_mfma_f32_16x16x32_bf16 v[80:83], v[16:19], v[44:47], v[80:83]
    ds_read_b64_tr_b16 v[30:31], v6 offset:4608
    s_waitcnt lgkmcnt(10)
    v_mfma_f32_16x16x32_bf16 v[84:87], v[20:23], v[44:47], v[84:87]
    ds_read_b64_tr_b16 v[32:33], v7 offset:4096
    s_waitcnt lgkmcnt(8)
    v_mfma_f32_16x16x32_bf16 v[88:91], v[24:27], v[44:47], v[88:91]
    ds_read_b128 v[44:47], v3 offset:0
    v_mfma_f32_16x16x32_bf16 v[92:95], v[12:15], v[48:51], v[92:95]
    ds_read_b64_tr_b16 v[34:35], v7 offset:4608
    v_mfma_f32_16x16x32_bf16 v[96:99], v[16:19], v[48:51], v[96:99]
    ds_read_b64_tr_b16 v[36:37], v6 offset:12288
    v_mfma_f32_16x16x32_bf16 v[100:103], v[20:23], v[48:51], v[100:103]
    ds_read_b64_tr_b16 v[38:39], v6 offset:12800
    v_mfma_f32_16x16x32_bf16 v[104:107], v[24:27], v[48:51], v[104:107]
    ds_read_b128 v[48:51], v3 offset:2048
    v_mfma_f32_16x16x32_bf16 v[108:111], v[12:15], v[52:55], v[108:111]
    ds_read_b64_tr_b16 v[40:41], v7 offset:12288
    v_mfma_f32_16x16x32_bf16 v[112:115], v[16:19], v[52:55], v[112:115]
    ds_read_b64_tr_b16 v[42:43], v7 offset:12800
    v_mfma_f32_16x16x32_bf16 v[116:119], v[20:23], v[52:55], v[116:119]
    v_mfma_f32_16x16x32_bf16 v[120:123], v[24:27], v[52:55], v[120:123]
    ds_read_b128 v[52:55], v3 offset:4096
    s_waitcnt lgkmcnt(14)
    v_mfma_f32_16x16x32_bf16 v[124:127], v[12:15], v[56:59], v[124:127]
    v_mfma_f32_16x16x32_bf16 v[128:131], v[16:19], v[56:59], v[128:131]
    v_mfma_f32_16x16x32_bf16 v[132:135], v[20:23], v[56:59], v[132:135]
    v_mfma_f32_16x16x32_bf16 v[136:139], v[24:27], v[56:59], v[136:139]
    ds_read_b128 v[56:59], v3 offset:6144
    s_waitcnt lgkmcnt(14)
    v_mfma_f32_16x16x32_bf16 v[140:143], v[12:15], v[60:63], v[140:143]
    v_mfma_f32_16x16x32_bf16 v[144:147], v[16:19], v[60:63], v[144:147]
    v_mfma_f32_16x16x32_bf16 v[148:151], v[20:23], v[60:63], v[148:151]
    v_mfma_f32_16x16x32_bf16 v[152:155], v[24:27], v[60:63], v[152:155]
    ds_read_b128 v[60:63], v3 offset:8192
    s_waitcnt lgkmcnt(14)
    v_mfma_f32_16x16x32_bf16 v[156:159], v[12:15], v[64:67], v[156:159]
    v_mfma_f32_16x16x32_bf16 v[160:163], v[16:19], v[64:67], v[160:163]
    v_mfma_f32_16x16x32_bf16 v[164:167], v[20:23], v[64:67], v[164:167]
    v_mfma_f32_16x16x32_bf16 v[168:171], v[24:27], v[64:67], v[168:171]
    ds_read_b128 v[64:67], v3 offset:10240
    s_waitcnt lgkmcnt(14)
    v_mfma_f32_16x16x32_bf16 v[172:175], v[12:15], v[68:71], v[172:175]
    v_mfma_f32_16x16x32_bf16 v[176:179], v[16:19], v[68:71], v[176:179]
    v_mfma_f32_16x16x32_bf16 v[180:183], v[20:23], v[68:71], v[180:183]
    v_mfma_f32_16x16x32_bf16 v[184:187], v[24:27], v[68:71], v[184:187]
    ds_read_b128 v[68:71], v3 offset:12288
    s_waitcnt lgkmcnt(14)
    v_mfma_f32_16x16x32_bf16 v[188:191], v[12:15], v[72:75], v[188:191]
    v_mfma_f32_16x16x32_bf16 v[192:195], v[16:19], v[72:75], v[192:195]
    v_mfma_f32_16x16x32_bf16 v[196:199], v[20:23], v[72:75], v[196:199]
    v_mfma_f32_16x16x32_bf16 v[200:203], v[24:27], v[72:75], v[200:203]
    ds_read_b128 v[72:75], v3 offset:14336
    s_waitcnt lgkmcnt(12)
    v_mfma_f32_16x16x32_bf16 v[76:79], v[28:31], v[44:47], v[76:79]
    s_waitcnt lgkmcnt(11)
    v_mfma_f32_16x16x32_bf16 v[80:83], v[32:35], v[44:47], v[80:83]
    s_waitcnt lgkmcnt(9)
    v_mfma_f32_16x16x32_bf16 v[84:87], v[36:39], v[44:47], v[84:87]
    s_waitcnt lgkmcnt(6)
    v_mfma_f32_16x16x32_bf16 v[88:91], v[40:43], v[44:47], v[88:91]
    s_waitcnt lgkmcnt(0)
    s_barrier
    ds_read_b128 v[44:47], v4 offset:0
    v_mfma_f32_16x16x32_bf16 v[92:95], v[28:31], v[48:51], v[92:95]
    ds_read_b64_tr_b16 v[12:13], v8 offset:0
    v_mfma_f32_16x16x32_bf16 v[96:99], v[32:35], v[48:51], v[96:99]
    ds_read_b64_tr_b16 v[14:15], v8 offset:512
    v_mfma_f32_16x16x32_bf16 v[100:103], v[36:39], v[48:51], v[100:103]
    ds_read_b64_tr_b16 v[16:17], v9 offset:0
    v_mfma_f32_16x16x32_bf16 v[104:107], v[40:43], v[48:51], v[104:107]
    ds_read_b128 v[48:51], v4 offset:2048
    v_mfma_f32_16x16x32_bf16 v[108:111], v[28:31], v[52:55], v[108:111]
    ds_read_b64_tr_b16 v[18:19], v9 offset:512
    v_mfma_f32_16x16x32_bf16 v[112:115], v[32:35], v[52:55], v[112:115]
    ds_read_b64_tr_b16 v[20:21], v8 offset:8192
    v_mfma_f32_16x16x32_bf16 v[116:119], v[36:39], v[52:55], v[116:119]
    ds_read_b64_tr_b16 v[22:23], v8 offset:8704
    v_mfma_f32_16x16x32_bf16 v[120:123], v[40:43], v[52:55], v[120:123]
    ds_read_b128 v[52:55], v4 offset:4096
    v_mfma_f32_16x16x32_bf16 v[124:127], v[28:31], v[56:59], v[124:127]
    ds_read_b64_tr_b16 v[24:25], v9 offset:8192
    v_mfma_f32_16x16x32_bf16 v[128:131], v[32:35], v[56:59], v[128:131]
    ds_read_b64_tr_b16 v[26:27], v9 offset:8704
    v_mfma_f32_16x16x32_bf16 v[132:135], v[36:39], v[56:59], v[132:135]
    v_mfma_f32_16x16x32_bf16 v[136:139], v[40:43], v[56:59], v[136:139]
    ds_read_b128 v[56:59], v4 offset:6144
    v_mfma_f32_16x16x32_bf16 v[140:143], v[28:31], v[60:63], v[140:143]
    v_mfma_f32_16x16x32_bf16 v[144:147], v[32:35], v[60:63], v[144:147]
    v_mfma_f32_16x16x32_bf16 v[148:151], v[36:39], v[60:63], v[148:151]
    v_mfma_f32_16x16x32_bf16 v[152:155], v[40:43], v[60:63], v[152:155]
    ds_read_b128 v[60:63], v4 offset:8192
    v_mfma_f32_16x16x32_bf16 v[156:159], v[28:31], v[64:67], v[156:159]
    v_mfma_f32_16x16x32_bf16 v[160:163], v[32:35], v[64:67], v[160:163]
    v_mfma_f32_16x16x32_bf16 v[164:167], v[36:39], v[64:67], v[164:167]
    v_mfma_f32_16x16x32_bf16 v[168:171], v[40:43], v[64:67], v[168:171]
    ds_read_b128 v[64:67], v4 offset:10240
    v_mfma_f32_16x16x32_bf16 v[172:175], v[28:31], v[68:71], v[172:175]
    v_mfma_f32_16x16x32_bf16 v[176:179], v[32:35], v[68:71], v[176:179]
    v_mfma_f32_16x16x32_bf16 v[180:183], v[36:39], v[68:71], v[180:183]
    v_mfma_f32_16x16x32_bf16 v[184:187], v[40:43], v[68:71], v[184:187]
    ds_read_b128 v[68:71], v4 offset:12288
    v_mfma_f32_16x16x32_bf16 v[188:191], v[28:31], v[72:75], v[188:191]
    v_mfma_f32_16x16x32_bf16 v[192:195], v[32:35], v[72:75], v[192:195]
    v_mfma_f32_16x16x32_bf16 v[196:199], v[36:39], v[72:75], v[196:199]
    v_mfma_f32_16x16x32_bf16 v[200:203], v[40:43], v[72:75], v[200:203]
    ds_read_b128 v[72:75], v4 offset:14336
    s_waitcnt lgkmcnt(13)
    v_mfma_f32_16x16x32_bf16 v[76:79], v[12:15], v[44:47], v[76:79]
    ds_read_b64_tr_b16 v[28:29], v8 offset:4096
    s_waitcnt lgkmcnt(11)
    v_mfma_f32_16x16x32_bf16 v[80:83], v[16:19], v[44:47], v[80:83]
    ds_read_b64_tr_b16 v[30:31], v8 offset:4608
    s_waitcnt lgkmcnt(10)
    v_mfma_f32_16x16x32_bf16 v[84:87], v[20:23], v[44:47], v[84:87]
    ds_read_b64_tr_b16 v[32:33], v9 offset:4096
    s_waitcnt lgkmcnt(8)
    v_mfma_f32_16x16x32_bf16 v[88:91], v[24:27], v[44:47], v[88:91]
    ds_read_b128 v[44:47], v5 offset:0
    v_mfma_f32_16x16x32_bf16 v[92:95], v[12:15], v[48:51], v[92:95]
    ds_read_b64_tr_b16 v[34:35], v9 offset:4608
    v_mfma_f32_16x16x32_bf16 v[96:99], v[16:19], v[48:51], v[96:99]
    ds_read_b64_tr_b16 v[36:37], v8 offset:12288
    v_mfma_f32_16x16x32_bf16 v[100:103], v[20:23], v[48:51], v[100:103]
    ds_read_b64_tr_b16 v[38:39], v8 offset:12800
    v_mfma_f32_16x16x32_bf16 v[104:107], v[24:27], v[48:51], v[104:107]
    ds_read_b128 v[48:51], v5 offset:2048
    v_mfma_f32_16x16x32_bf16 v[108:111], v[12:15], v[52:55], v[108:111]
    ds_read_b64_tr_b16 v[40:41], v9 offset:12288
    v_mfma_f32_16x16x32_bf16 v[112:115], v[16:19], v[52:55], v[112:115]
    ds_read_b64_tr_b16 v[42:43], v9 offset:12800
    v_mfma_f32_16x16x32_bf16 v[116:119], v[20:23], v[52:55], v[116:119]
    v_mfma_f32_16x16x32_bf16 v[120:123], v[24:27], v[52:55], v[120:123]
    ds_read_b128 v[52:55], v5 offset:4096
    s_waitcnt lgkmcnt(14)
    v_mfma_f32_16x16x32_bf16 v[124:127], v[12:15], v[56:59], v[124:127]
    v_mfma_f32_16x16x32_bf16 v[128:131], v[16:19], v[56:59], v[128:131]
    v_mfma_f32_16x16x32_bf16 v[132:135], v[20:23], v[56:59], v[132:135]
    v_mfma_f32_16x16x32_bf16 v[136:139], v[24:27], v[56:59], v[136:139]
    ds_read_b128 v[56:59], v5 offset:6144
    s_waitcnt lgkmcnt(14)
    v_mfma_f32_16x16x32_bf16 v[140:143], v[12:15], v[60:63], v[140:143]
    v_mfma_f32_16x16x32_bf16 v[144:147], v[16:19], v[60:63], v[144:147]
    v_mfma_f32_16x16x32_bf16 v[148:151], v[20:23], v[60:63], v[148:151]
    v_mfma_f32_16x16x32_bf16 v[152:155], v[24:27], v[60:63], v[152:155]
    ds_read_b128 v[60:63], v5 offset:8192
    s_waitcnt lgkmcnt(14)
    v_mfma_f32_16x16x32_bf16 v[156:159], v[12:15], v[64:67], v[156:159]
    v_mfma_f32_16x16x32_bf16 v[160:163], v[16:19], v[64:67], v[160:163]
    v_mfma_f32_16x16x32_bf16 v[164:167], v[20:23], v[64:67], v[164:167]
    v_mfma_f32_16x16x32_bf16 v[168:171], v[24:27], v[64:67], v[168:171]
    ds_read_b128 v[64:67], v5 offset:10240
    s_waitcnt lgkmcnt(14)
    v_mfma_f32_16x16x32_bf16 v[172:175], v[12:15], v[68:71], v[172:175]
    v_mfma_f32_16x16x32_bf16 v[176:179], v[16:19], v[68:71], v[176:179]
    v_mfma_f32_16x16x32_bf16 v[180:183], v[20:23], v[68:71], v[180:183]
    v_mfma_f32_16x16x32_bf16 v[184:187], v[24:27], v[68:71], v[184:187]
    ds_read_b128 v[68:71], v5 offset:12288
    s_waitcnt lgkmcnt(14)
    v_mfma_f32_16x16x32_bf16 v[188:191], v[12:15], v[72:75], v[188:191]
    v_mfma_f32_16x16x32_bf16 v[192:195], v[16:19], v[72:75], v[192:195]
    v_mfma_f32_16x16x32_bf16 v[196:199], v[20:23], v[72:75], v[196:199]
    v_mfma_f32_16x16x32_bf16 v[200:203], v[24:27], v[72:75], v[200:203]
    ds_read_b128 v[72:75], v5 offset:14336
    s_waitcnt lgkmcnt(12)
    v_mfma_f32_16x16x32_bf16 v[76:79], v[28:31], v[44:47], v[76:79]
    s_waitcnt lgkmcnt(11)
    v_mfma_f32_16x16x32_bf16 v[80:83], v[32:35], v[44:47], v[80:83]
    s_waitcnt lgkmcnt(9)
    v_mfma_f32_16x16x32_bf16 v[84:87], v[36:39], v[44:47], v[84:87]
    s_waitcnt lgkmcnt(6)
    v_mfma_f32_16x16x32_bf16 v[88:91], v[40:43], v[44:47], v[88:91]
    s_waitcnt lgkmcnt(0)
    s_barrier
    ds_read_b128 v[44:47], v2 offset:49152
    v_mfma_f32_16x16x32_bf16 v[92:95], v[28:31], v[48:51], v[92:95]
    ds_read_b64_tr_b16 v[12:13], v6 offset:49152
    v_mfma_f32_16x16x32_bf16 v[96:99], v[32:35], v[48:51], v[96:99]
    ds_read_b64_tr_b16 v[14:15], v6 offset:49664
    v_mfma_f32_16x16x32_bf16 v[100:103], v[36:39], v[48:51], v[100:103]
    ds_read_b64_tr_b16 v[16:17], v7 offset:49152
    v_mfma_f32_16x16x32_bf16 v[104:107], v[40:43], v[48:51], v[104:107]
    ds_read_b128 v[48:51], v2 offset:51200
    v_mfma_f32_16x16x32_bf16 v[108:111], v[28:31], v[52:55], v[108:111]
    ds_read_b64_tr_b16 v[18:19], v7 offset:49664
    v_mfma_f32_16x16x32_bf16 v[112:115], v[32:35], v[52:55], v[112:115]
    ds_read_b64_tr_b16 v[20:21], v6 offset:57344
    v_mfma_f32_16x16x32_bf16 v[116:119], v[36:39], v[52:55], v[116:119]
    ds_read_b64_tr_b16 v[22:23], v6 offset:57856
    v_mfma_f32_16x16x32_bf16 v[120:123], v[40:43], v[52:55], v[120:123]
    ds_read_b128 v[52:55], v2 offset:53248
    v_mfma_f32_16x16x32_bf16 v[124:127], v[28:31], v[56:59], v[124:127]
    ds_read_b64_tr_b16 v[24:25], v7 offset:57344
    v_mfma_f32_16x16x32_bf16 v[128:131], v[32:35], v[56:59], v[128:131]
    ds_read_b64_tr_b16 v[26:27], v7 offset:57856
    v_mfma_f32_16x16x32_bf16 v[132:135], v[36:39], v[56:59], v[132:135]
    v_mfma_f32_16x16x32_bf16 v[136:139], v[40:43], v[56:59], v[136:139]
    ds_read_b128 v[56:59], v2 offset:55296
    v_mfma_f32_16x16x32_bf16 v[140:143], v[28:31], v[60:63], v[140:143]
    v_mfma_f32_16x16x32_bf16 v[144:147], v[32:35], v[60:63], v[144:147]
    v_mfma_f32_16x16x32_bf16 v[148:151], v[36:39], v[60:63], v[148:151]
    v_mfma_f32_16x16x32_bf16 v[152:155], v[40:43], v[60:63], v[152:155]
    ds_read_b128 v[60:63], v2 offset:57344
    v_mfma_f32_16x16x32_bf16 v[156:159], v[28:31], v[64:67], v[156:159]
    v_mfma_f32_16x16x32_bf16 v[160:163], v[32:35], v[64:67], v[160:163]
    v_mfma_f32_16x16x32_bf16 v[164:167], v[36:39], v[64:67], v[164:167]
    v_mfma_f32_16x16x32_bf16 v[168:171], v[40:43], v[64:67], v[168:171]
    ds_read_b128 v[64:67], v2 offset:59392
    v_mfma_f32_16x16x32_bf16 v[172:175], v[28:31], v[68:71], v[172:175]
    v_mfma_f32_16x16x32_bf16 v[176:179], v[32:35], v[68:71], v[176:179]
    v_mfma_f32_16x16x32_bf16 v[180:183], v[36:39], v[68:71], v[180:183]
    v_mfma_f32_16x16x32_bf16 v[184:187], v[40:43], v[68:71], v[184:187]
    ds_read_b128 v[68:71], v2 offset:61440
    v_mfma_f32_16x16x32_bf16 v[188:191], v[28:31], v[72:75], v[188:191]
    v_mfma_f32_16x16x32_bf16 v[192:195], v[32:35], v[72:75], v[192:195]
    v_mfma_f32_16x16x32_bf16 v[196:199], v[36:39], v[72:75], v[196:199]
    v_mfma_f32_16x16x32_bf16 v[200:203], v[40:43], v[72:75], v[200:203]
    ds_read_b128 v[72:75], v2 offset:63488
    s_waitcnt lgkmcnt(13)
    v_mfma_f32_16x16x32_bf16 v[76:79], v[12:15], v[44:47], v[76:79]
    ds_read_b64_tr_b16 v[28:29], v6 offset:53248
    s_waitcnt lgkmcnt(11)
    v_mfma_f32_16x16x32_bf16 v[80:83], v[16:19], v[44:47], v[80:83]
    ds_read_b64_tr_b16 v[30:31], v6 offset:53760
    s_waitcnt lgkmcnt(10)
    v_mfma_f32_16x16x32_bf16 v[84:87], v[20:23], v[44:47], v[84:87]
    ds_read_b64_tr_b16 v[32:33], v7 offset:53248
    s_waitcnt lgkmcnt(8)
    v_mfma_f32_16x16x32_bf16 v[88:91], v[24:27], v[44:47], v[88:91]
    ds_read_b128 v[44:47], v3 offset:49152
    v_mfma_f32_16x16x32_bf16 v[92:95], v[12:15], v[48:51], v[92:95]
    ds_read_b64_tr_b16 v[34:35], v7 offset:53760
    v_mfma_f32_16x16x32_bf16 v[96:99], v[16:19], v[48:51], v[96:99]
    ds_read_b64_tr_b16 v[36:37], v6 offset:61440
    v_mfma_f32_16x16x32_bf16 v[100:103], v[20:23], v[48:51], v[100:103]
    ds_read_b64_tr_b16 v[38:39], v6 offset:61952
    v_mfma_f32_16x16x32_bf16 v[104:107], v[24:27], v[48:51], v[104:107]
    ds_read_b128 v[48:51], v3 offset:51200
    v_mfma_f32_16x16x32_bf16 v[108:111], v[12:15], v[52:55], v[108:111]
    ds_read_b64_tr_b16 v[40:41], v7 offset:61440
    v_mfma_f32_16x16x32_bf16 v[112:115], v[16:19], v[52:55], v[112:115]
    ds_read_b64_tr_b16 v[42:43], v7 offset:61952
    v_mfma_f32_16x16x32_bf16 v[116:119], v[20:23], v[52:55], v[116:119]
    v_mfma_f32_16x16x32_bf16 v[120:123], v[24:27], v[52:55], v[120:123]
    ds_read_b128 v[52:55], v3 offset:53248
    s_waitcnt lgkmcnt(14)
    v_mfma_f32_16x16x32_bf16 v[124:127], v[12:15], v[56:59], v[124:127]
    v_mfma_f32_16x16x32_bf16 v[128:131], v[16:19], v[56:59], v[128:131]
    v_mfma_f32_16x16x32_bf16 v[132:135], v[20:23], v[56:59], v[132:135]
    v_mfma_f32_16x16x32_bf16 v[136:139], v[24:27], v[56:59], v[136:139]
    ds_read_b128 v[56:59], v3 offset:55296
    s_waitcnt lgkmcnt(14)
    v_mfma_f32_16x16x32_bf16 v[140:143], v[12:15], v[60:63], v[140:143]
    v_mfma_f32_16x16x32_bf16 v[144:147], v[16:19], v[60:63], v[144:147]
    v_mfma_f32_16x16x32_bf16 v[148:151], v[20:23], v[60:63], v[148:151]
    v_mfma_f32_16x16x32_bf16 v[152:155], v[24:27], v[60:63], v[152:155]
    ds_read_b128 v[60:63], v3 offset:57344
    s_waitcnt lgkmcnt(14)
    v_mfma_f32_16x16x32_bf16 v[156:159], v[12:15], v[64:67], v[156:159]
    v_mfma_f32_16x16x32_bf16 v[160:163], v[16:19], v[64:67], v[160:163]
    v_mfma_f32_16x16x32_bf16 v[164:167], v[20:23], v[64:67], v[164:167]
    v_mfma_f32_16x16x32_bf16 v[168:171], v[24:27], v[64:67], v[168:171]
    ds_read_b128 v[64:67], v3 offset:59392
    s_waitcnt lgkmcnt(14)
    v_mfma_f32_16x16x32_bf16 v[172:175], v[12:15], v[68:71], v[172:175]
    v_mfma_f32_16x16x32_bf16 v[176:179], v[16:19], v[68:71], v[176:179]
    v_mfma_f32_16x16x32_bf16 v[180:183], v[20:23], v[68:71], v[180:183]
    v_mfma_f32_16x16x32_bf16 v[184:187], v[24:27], v[68:71], v[184:187]
    ds_read_b128 v[68:71], v3 offset:61440
    s_waitcnt lgkmcnt(14)
    v_mfma_f32_16x16x32_bf16 v[188:191], v[12:15], v[72:75], v[188:191]
    v_mfma_f32_16x16x32_bf16 v[192:195], v[16:19], v[72:75], v[192:195]
    v_mfma_f32_16x16x32_bf16 v[196:199], v[20:23], v[72:75], v[196:199]
    v_mfma_f32_16x16x32_bf16 v[200:203], v[24:27], v[72:75], v[200:203]
    ds_read_b128 v[72:75], v3 offset:63488
    s_waitcnt lgkmcnt(12)
    v_mfma_f32_16x16x32_bf16 v[76:79], v[28:31], v[44:47], v[76:79]
    s_waitcnt lgkmcnt(11)
    v_mfma_f32_16x16x32_bf16 v[80:83], v[32:35], v[44:47], v[80:83]
    s_waitcnt lgkmcnt(9)
    v_mfma_f32_16x16x32_bf16 v[84:87], v[36:39], v[44:47], v[84:87]
    s_waitcnt lgkmcnt(6)
    v_mfma_f32_16x16x32_bf16 v[88:91], v[40:43], v[44:47], v[88:91]
    s_waitcnt lgkmcnt(0)
    s_barrier
    ds_read_b128 v[44:47], v2 offset:0
    v_mfma_f32_16x16x32_bf16 v[92:95], v[28:31], v[48:51], v[92:95]
    ds_read_b64_tr_b16 v[12:13], v6 offset:0
    v_mfma_f32_16x16x32_bf16 v[96:99], v[32:35], v[48:51], v[96:99]
    ds_read_b64_tr_b16 v[14:15], v6 offset:512
    v_mfma_f32_16x16x32_bf16 v[100:103], v[36:39], v[48:51], v[100:103]
    ds_read_b64_tr_b16 v[16:17], v7 offset:0
    v_mfma_f32_16x16x32_bf16 v[104:107], v[40:43], v[48:51], v[104:107]
    ds_read_b128 v[48:51], v2 offset:2048
    v_mfma_f32_16x16x32_bf16 v[108:111], v[28:31], v[52:55], v[108:111]
    ds_read_b64_tr_b16 v[18:19], v7 offset:512
    v_mfma_f32_16x16x32_bf16 v[112:115], v[32:35], v[52:55], v[112:115]
    ds_read_b64_tr_b16 v[20:21], v6 offset:8192
    v_mfma_f32_16x16x32_bf16 v[116:119], v[36:39], v[52:55], v[116:119]
    ds_read_b64_tr_b16 v[22:23], v6 offset:8704
    v_mfma_f32_16x16x32_bf16 v[120:123], v[40:43], v[52:55], v[120:123]
    ds_read_b128 v[52:55], v2 offset:4096
    v_mfma_f32_16x16x32_bf16 v[124:127], v[28:31], v[56:59], v[124:127]
    ds_read_b64_tr_b16 v[24:25], v7 offset:8192
    v_mfma_f32_16x16x32_bf16 v[128:131], v[32:35], v[56:59], v[128:131]
    ds_read_b64_tr_b16 v[26:27], v7 offset:8704
    v_mfma_f32_16x16x32_bf16 v[132:135], v[36:39], v[56:59], v[132:135]
    v_mfma_f32_16x16x32_bf16 v[136:139], v[40:43], v[56:59], v[136:139]
    ds_read_b128 v[56:59], v3 offset:0
    v_mfma_f32_16x16x32_bf16 v[140:143], v[28:31], v[60:63], v[140:143]
    v_mfma_f32_16x16x32_bf16 v[144:147], v[32:35], v[60:63], v[144:147]
    v_mfma_f32_16x16x32_bf16 v[148:151], v[36:39], v[60:63], v[148:151]
    v_mfma_f32_16x16x32_bf16 v[152:155], v[40:43], v[60:63], v[152:155]
    ds_read_b128 v[60:63], v3 offset:2048
    v_mfma_f32_16x16x32_bf16 v[156:159], v[28:31], v[64:67], v[156:159]
    v_mfma_f32_16x16x32_bf16 v[160:163], v[32:35], v[64:67], v[160:163]
    v_mfma_f32_16x16x32_bf16 v[164:167], v[36:39], v[64:67], v[164:167]
    v_mfma_f32_16x16x32_bf16 v[168:171], v[40:43], v[64:67], v[168:171]
    ds_read_b128 v[64:67], v3 offset:4096
    v_mfma_f32_16x16x32_bf16 v[172:175], v[28:31], v[68:71], v[172:175]
    v_mfma_f32_16x16x32_bf16 v[176:179], v[32:35], v[68:71], v[176:179]
    v_mfma_f32_16x16x32_bf16 v[180:183], v[36:39], v[68:71], v[180:183]
    v_mfma_f32_16x16x32_bf16 v[184:187], v[40:43], v[68:71], v[184:187]
    ds_read_b128 v[68:71], v2 offset:6144
    v_mfma_f32_16x16x32_bf16 v[188:191], v[28:31], v[72:75], v[188:191]
    v_mfma_f32_16x16x32_bf16 v[192:195], v[32:35], v[72:75], v[192:195]
    v_mfma_f32_16x16x32_bf16 v[196:199], v[36:39], v[72:75], v[196:199]
    v_mfma_f32_16x16x32_bf16 v[200:203], v[40:43], v[72:75], v[200:203]
    ds_read_b128 v[72:75], v3 offset:6144
    s_setprio 3
    s_waitcnt lgkmcnt(13)
    v_mfma_f32_16x16x32_bf16 v[76:79], v[12:15], v[44:47], v[76:79]
    ds_read_b64_tr_b16 v[28:29], v6 offset:4096
    ds_read_b64_tr_b16 v[30:31], v6 offset:4608
    s_waitcnt lgkmcnt(12)
    v_mfma_f32_16x16x32_bf16 v[80:83], v[16:19], v[44:47], v[80:83]
    ds_read_b64_tr_b16 v[32:33], v7 offset:4096
    ds_read_b64_tr_b16 v[34:35], v7 offset:4608
    s_waitcnt lgkmcnt(12)
    v_mfma_f32_16x16x32_bf16 v[84:87], v[20:23], v[44:47], v[84:87]
    ds_read_b64_tr_b16 v[36:37], v6 offset:12288
    ds_read_b64_tr_b16 v[38:39], v6 offset:12800
    s_waitcnt lgkmcnt(11)
    v_mfma_f32_16x16x32_bf16 v[88:91], v[24:27], v[44:47], v[88:91]
    ds_read_b128 v[44:47], v2 offset:8192
    v_mfma_f32_16x16x32_bf16 v[92:95], v[12:15], v[48:51], v[92:95]
    ds_read_b64_tr_b16 v[40:41], v7 offset:12288
    v_mfma_f32_16x16x32_bf16 v[96:99], v[16:19], v[48:51], v[96:99]
    ds_read_b64_tr_b16 v[42:43], v7 offset:12800
    v_mfma_f32_16x16x32_bf16 v[100:103], v[20:23], v[48:51], v[100:103]
    v_mfma_f32_16x16x32_bf16 v[104:107], v[24:27], v[48:51], v[104:107]
    ds_read_b128 v[48:51], v3 offset:8192
    v_mfma_f32_16x16x32_bf16 v[108:111], v[12:15], v[52:55], v[108:111]
    v_mfma_f32_16x16x32_bf16 v[112:115], v[16:19], v[52:55], v[112:115]
    v_mfma_f32_16x16x32_bf16 v[116:119], v[20:23], v[52:55], v[116:119]
    v_mfma_f32_16x16x32_bf16 v[120:123], v[24:27], v[52:55], v[120:123]
    ds_read_b128 v[52:55], v2 offset:10240
    s_waitcnt lgkmcnt(9)
    v_mfma_f32_16x16x32_bf16 v[76:79], v[28:31], v[56:59], v[76:79]
    s_waitcnt lgkmcnt(7)
    v_mfma_f32_16x16x32_bf16 v[80:83], v[32:35], v[56:59], v[80:83]
    s_waitcnt lgkmcnt(5)
    v_mfma_f32_16x16x32_bf16 v[84:87], v[36:39], v[56:59], v[84:87]
    s_waitcnt lgkmcnt(2)
    v_mfma_f32_16x16x32_bf16 v[88:91], v[40:43], v[56:59], v[88:91]
    ds_read_b128 v[56:59], v3 offset:10240
    v_mfma_f32_16x16x32_bf16 v[92:95], v[28:31], v[60:63], v[92:95]
    v_mfma_f32_16x16x32_bf16 v[96:99], v[32:35], v[60:63], v[96:99]
    v_mfma_f32_16x16x32_bf16 v[100:103], v[36:39], v[60:63], v[100:103]
    v_mfma_f32_16x16x32_bf16 v[104:107], v[40:43], v[60:63], v[104:107]
    ds_read_b128 v[60:63], v2 offset:12288
    v_mfma_f32_16x16x32_bf16 v[108:111], v[28:31], v[64:67], v[108:111]
    v_mfma_f32_16x16x32_bf16 v[112:115], v[32:35], v[64:67], v[112:115]
    v_mfma_f32_16x16x32_bf16 v[116:119], v[36:39], v[64:67], v[116:119]
    v_mul_f32 v204, s60, v76
    v_mul_f32 v205, s60, v77
    v_mul_f32 v206, s60, v78
    v_mul_f32 v207, s60, v79
    v_mul_f32 v208, s60, v80
    v_mul_f32 v209, s60, v81
    v_mfma_f32_16x16x32_bf16 v[120:123], v[40:43], v[64:67], v[120:123]
    ds_read_b128 v[64:67], v3 offset:12288
    v_exp_f32 v204, v204
    v_exp_f32 v205, v205
    v_mul_f32 v76, v84, v76
    v_mul_f32 v77, v85, v77
    v_mul_f32 v210, s60, v82
    v_mul_f32 v211, s60, v83
    v_mfma_f32_16x16x32_bf16 v[124:127], v[12:15], v[68:71], v[124:127]
    v_exp_f32 v206, v206
    v_exp_f32 v207, v207
    v_mul_f32 v78, v86, v78
    v_mul_f32 v79, v87, v79
    v_mul_f32 v212, s60, v92
    v_mul_f32 v213, s60, v93
    v_mfma_f32_16x16x32_bf16 v[128:131], v[16:19], v[68:71], v[128:131]
    v_exp_f32 v208, v208
    v_exp_f32 v209, v209
    v_mul_f32 v80, v88, v80
    v_mul_f32 v81, v89, v81
    v_add_f32 v204, 1.0, v204
    v_add_f32 v205, 1.0, v205
    v_mfma_f32_16x16x32_bf16 v[132:135], v[20:23], v[68:71], v[132:135]
    v_mul_f32 v214, s60, v94
    v_mul_f32 v215, s60, v95
    v_exp_f32 v210, v210
    v_exp_f32 v211, v211
    v_mul_f32 v82, v90, v82
    v_mul_f32 v83, v91, v83
    v_mfma_f32_16x16x32_bf16 v[136:139], v[24:27], v[68:71], v[136:139]
    ds_read_b128 v[68:71], v2 offset:14336
    v_add_f32 v206, 1.0, v206
    v_add_f32 v207, 1.0, v207
    v_rcp_f32 v204, v204
    v_rcp_f32 v205, v205
    v_mul_f32 v216, s60, v96
    v_mul_f32 v217, s60, v97
    v_mfma_f32_16x16x32_bf16 v[124:127], v[28:31], v[72:75], v[124:127]
    v_exp_f32 v212, v212
    v_exp_f32 v213, v213
    v_mul_f32 v92, v100, v92
    v_mul_f32 v93, v101, v93
    v_add_f32 v208, 1.0, v208
    v_add_f32 v209, 1.0, v209
    v_mfma_f32_16x16x32_bf16 v[128:131], v[32:35], v[72:75], v[128:131]
    v_rcp_f32 v206, v206
    v_rcp_f32 v207, v207
    v_mul_f32 v218, s60, v98
    v_mul_f32 v219, s60, v99
    v_exp_f32 v214, v214
    v_exp_f32 v215, v215
    v_mfma_f32_16x16x32_bf16 v[132:135], v[36:39], v[72:75], v[132:135]
    v_mul_f32 v94, v102, v94
    v_mul_f32 v95, v103, v95
    v_add_f32 v210, 1.0, v210
    v_add_f32 v211, 1.0, v211
    v_rcp_f32 v208, v208
    v_rcp_f32 v209, v209
    v_mfma_f32_16x16x32_bf16 v[136:139], v[40:43], v[72:75], v[136:139]
    ds_read_b128 v[72:75], v3 offset:14336
    v_mul_f32 v76, v204, v76
    v_mul_f32 v77, v205, v77
    v_mul_f32 v220, s60, v108
    v_mul_f32 v221, s60, v109
    v_exp_f32 v216, v216
    v_exp_f32 v217, v217
    v_mfma_f32_16x16x32_bf16 v[140:143], v[12:15], v[44:47], v[140:143]
    v_mul_f32 v96, v104, v96
    v_mul_f32 v97, v105, v97
    v_add_f32 v212, 1.0, v212
    v_add_f32 v213, 1.0, v213
    v_rcp_f32 v210, v210
    v_rcp_f32 v211, v211
    v_mfma_f32_16x16x32_bf16 v[144:147], v[16:19], v[44:47], v[144:147]
    v_mul_f32 v78, v206, v78
    v_mul_f32 v79, v207, v79
    v_cvt_pk_bf16_f32 v84, v76, v77
    v_mul_f32 v222, s60, v110
    v_mul_f32 v223, s60, v111
    v_exp_f32 v218, v218
    v_mfma_f32_16x16x32_bf16 v[148:151], v[20:23], v[44:47], v[148:151]
    v_exp_f32 v219, v219
    v_mul_f32 v98, v106, v98
    v_mul_f32 v99, v107, v99
    v_add_f32 v214, 1.0, v214
    v_add_f32 v215, 1.0, v215
    v_rcp_f32 v212, v212
    v_mfma_f32_16x16x32_bf16 v[152:155], v[24:27], v[44:47], v[152:155]
    s_waitcnt lgkmcnt(0)
    s_mov_b64 exec, 1
    ds_add_u32 v254, v253 offset:24
    s_mov_b64 exec, -1
    v_rcp_f32 v213, v213
    v_mul_f32 v80, v208, v80
    v_mul_f32 v81, v209, v81
    v_cvt_pk_bf16_f32 v85, v78, v79
    v_mul_f32 v224, s60, v112
    v_mul_f32 v225, s60, v113
    v_mfma_f32_16x16x32_bf16 v[140:143], v[28:31], v[48:51], v[140:143]
    v_exp_f32 v220, v220
    v_exp_f32 v221, v221
    v_mul_f32 v108, v116, v108
    v_mul_f32 v109, v117, v109
    v_add_f32 v216, 1.0, v216
    v_add_f32 v217, 1.0, v217
    v_mfma_f32_16x16x32_bf16 v[144:147], v[32:35], v[48:51], v[144:147]
    v_rcp_f32 v214, v214
    v_rcp_f32 v215, v215
    v_mul_f32 v82, v210, v82
    v_mul_f32 v83, v211, v83
    v_cvt_pk_bf16_f32 v86, v80, v81
    v_mul_f32 v226, s60, v114
    v_mul_f32 v227, s60, v115
    v_mfma_f32_16x16x32_bf16 v[148:151], v[36:39], v[48:51], v[148:151]
    v_exp_f32 v222, v222
    v_exp_f32 v223, v223
    v_mul_f32 v110, v118, v110
    v_mul_f32 v111, v119, v111
    v_add_f32 v218, 1.0, v218
    v_add_f32 v219, 1.0, v219
    v_mfma_f32_16x16x32_bf16 v[152:155], v[40:43], v[48:51], v[152:155]
    v_rcp_f32 v216, v216
    v_rcp_f32 v217, v217
    v_mul_f32 v92, v212, v92
    v_mul_f32 v93, v213, v93
    v_cvt_pk_bf16_f32 v87, v82, v83
    buffer_store_dwordx4 v[84:87], v237, s[56:59], s63 offen offset:0 sc1
    v_mfma_f32_16x16x32_bf16 v[156:159], v[12:15], v[52:55], v[156:159]
    v_mul_f32 v204, s60, v124
    v_mul_f32 v205, s60, v125
    v_exp_f32 v224, v224
    v_exp_f32 v225, v225
    v_mul_f32 v112, v120, v112
    v_mul_f32 v113, v121, v113
    v_mfma_f32_16x16x32_bf16 v[160:163], v[16:19], v[52:55], v[160:163]
    v_add_f32 v220, 1.0, v220
    v_add_f32 v221, 1.0, v221
    v_rcp_f32 v218, v218
    v_rcp_f32 v219, v219
    v_mul_f32 v94, v214, v94
    v_mul_f32 v95, v215, v95
    v_mfma_f32_16x16x32_bf16 v[164:167], v[20:23], v[52:55], v[164:167]
    v_cvt_pk_bf16_f32 v100, v92, v93
    v_mul_f32 v206, s60, v126
    v_mul_f32 v207, s60, v127
    v_exp_f32 v226, v226
    v_exp_f32 v227, v227
    v_mul_f32 v114, v122, v114
    v_mul_f32 v115, v123, v115
    v_mfma_f32_16x16x32_bf16 v[168:171], v[24:27], v[52:55], v[168:171]
    v_add_f32 v222, 1.0, v222
    v_add_f32 v223, 1.0, v223
    v_rcp_f32 v220, v220
    v_rcp_f32 v221, v221
    v_mul_f32 v96, v216, v96
    v_mul_f32 v97, v217, v97
    v_mfma_f32_16x16x32_bf16 v[156:159], v[28:31], v[56:59], v[156:159]
    v_cvt_pk_bf16_f32 v101, v94, v95
    v_mul_f32 v208, s60, v128
    v_mul_f32 v209, s60, v129
    v_exp_f32 v204, v204
    v_exp_f32 v205, v205
    v_mul_f32 v124, v132, v124
    v_mul_f32 v125, v133, v125
    v_mfma_f32_16x16x32_bf16 v[160:163], v[32:35], v[56:59], v[160:163]
    v_add_f32 v224, 1.0, v224
    v_add_f32 v225, 1.0, v225
    v_rcp_f32 v222, v222
    v_rcp_f32 v223, v223
    v_mul_f32 v98, v218, v98
    v_mul_f32 v99, v219, v99
    v_mfma_f32_16x16x32_bf16 v[164:167], v[36:39], v[56:59], v[164:167]
    v_cvt_pk_bf16_f32 v102, v96, v97
    v_mul_f32 v210, s60, v130
    v_mul_f32 v211, s60, v131
    v_exp_f32 v206, v206
    v_exp_f32 v207, v207
    v_mul_f32 v126, v134, v126
    v_mul_f32 v127, v135, v127
    v_mfma_f32_16x16x32_bf16 v[168:171], v[40:43], v[56:59], v[168:171]
    v_add_f32 v226, 1.0, v226
    v_add_f32 v227, 1.0, v227
    v_rcp_f32 v224, v224
    v_rcp_f32 v225, v225
    v_mul_f32 v108, v220, v108
    v_mul_f32 v109, v221, v109
    v_mfma_f32_16x16x32_bf16 v[172:175], v[12:15], v[60:63], v[172:175]
    v_cvt_pk_bf16_f32 v103, v98, v99
    buffer_store_dwordx4 v[100:103], v237, s[56:59], s63 offen offset:1024 sc1
    v_mul_f32 v212, s60, v140
    v_mul_f32 v213, s60, v141
    v_exp_f32 v208, v208
    v_exp_f32 v209, v209
    v_mfma_f32_16x16x32_bf16 v[176:179], v[16:19], v[60:63], v[176:179]
    v_mul_f32 v128, v136, v128
    v_mul_f32 v129, v137, v129
    v_add_f32 v204, 1.0, v204
    v_add_f32 v205, 1.0, v205
    v_rcp_f32 v226, v226
    v_rcp_f32 v227, v227
    v_mfma_f32_16x16x32_bf16 v[180:183], v[20:23], v[60:63], v[180:183]
    v_mul_f32 v110, v222, v110
    v_mul_f32 v111, v223, v111
    v_cvt_pk_bf16_f32 v116, v108, v109
    v_mul_f32 v214, s60, v142
    v_mul_f32 v215, s60, v143
    v_exp_f32 v210, v210
    v_mfma_f32_16x16x32_bf16 v[184:187], v[24:27], v[60:63], v[184:187]
    v_exp_f32 v211, v211
    v_mul_f32 v130, v138, v130
    v_mul_f32 v131, v139, v131
    v_add_f32 v206, 1.0, v206
    v_add_f32 v207, 1.0, v207
    v_rcp_f32 v204, v204
    v_mfma_f32_16x16x32_bf16 v[172:175], v[28:31], v[64:67], v[172:175]
    v_rcp_f32 v205, v205
    v_mul_f32 v112, v224, v112
    v_mul_f32 v113, v225, v113
    v_cvt_pk_bf16_f32 v117, v110, v111
    v_mul_f32 v216, s60, v144
    v_mul_f32 v217, s60, v145
    v_mfma_f32_16x16x32_bf16 v[176:179], v[32:35], v[64:67], v[176:179]
    v_exp_f32 v212, v212
    v_exp_f32 v213, v213
    v_mul_f32 v140, v148, v140
    v_mul_f32 v141, v149, v141
    v_add_f32 v208, 1.0, v208
    v_add_f32 v209, 1.0, v209
    v_mfma_f32_16x16x32_bf16 v[180:183], v[36:39], v[64:67], v[180:183]
    v_rcp_f32 v206, v206
    v_rcp_f32 v207, v207
    v_mul_f32 v114, v226, v114
    v_mul_f32 v115, v227, v115
    v_cvt_pk_bf16_f32 v118, v112, v113
    v_mul_f32 v218, s60, v146
    v_mul_f32 v219, s60, v147
    v_mfma_f32_16x16x32_bf16 v[184:187], v[40:43], v[64:67], v[184:187]
    v_exp_f32 v214, v214
    v_exp_f32 v215, v215
    v_mul_f32 v142, v150, v142
    v_mul_f32 v143, v151, v143
    v_add_f32 v210, 1.0, v210
    v_add_f32 v211, 1.0, v211
    v_mfma_f32_16x16x32_bf16 v[188:191], v[12:15], v[68:71], v[188:191]
    v_rcp_f32 v208, v208
    v_rcp_f32 v209, v209
    v_mul_f32 v124, v204, v124
    v_mul_f32 v125, v205, v125
    v_cvt_pk_bf16_f32 v119, v114, v115
    buffer_store_dwordx4 v[116:119], v237, s[56:59], s63 offen offset:2048 sc1
    v_mfma_f32_16x16x32_bf16 v[192:195], v[16:19], v[68:71], v[192:195]
    v_mul_f32 v220, s60, v156
    v_mul_f32 v221, s60, v157
    v_exp_f32 v216, v216
    v_exp_f32 v217, v217
    v_mul_f32 v144, v152, v144
    v_mul_f32 v145, v153, v145
    v_mfma_f32_16x16x32_bf16 v[196:199], v[20:23], v[68:71], v[196:199]
    v_add_f32 v212, 1.0, v212
    v_add_f32 v213, 1.0, v213
    v_rcp_f32 v210, v210
    v_rcp_f32 v211, v211
    v_mul_f32 v126, v206, v126
    v_mul_f32 v127, v207, v127
    v_mfma_f32_16x16x32_bf16 v[200:203], v[24:27], v[68:71], v[200:203]
    v_cvt_pk_bf16_f32 v132, v124, v125
    v_mul_f32 v222, s60, v158
    v_mul_f32 v223, s60, v159
    v_exp_f32 v218, v218
    v_exp_f32 v219, v219
    v_mul_f32 v146, v154, v146
    v_mul_f32 v147, v155, v147
    v_mfma_f32_16x16x32_bf16 v[188:191], v[28:31], v[72:75], v[188:191]
    v_add_f32 v214, 1.0, v214
    v_add_f32 v215, 1.0, v215
    v_rcp_f32 v212, v212
    v_rcp_f32 v213, v213
    v_mul_f32 v128, v208, v128
    v_mul_f32 v129, v209, v129
    v_mfma_f32_16x16x32_bf16 v[192:195], v[32:35], v[72:75], v[192:195]
    v_cvt_pk_bf16_f32 v133, v126, v127
    v_mul_f32 v224, s60, v160
    v_mul_f32 v225, s60, v161
    v_exp_f32 v220, v220
    v_exp_f32 v221, v221
    v_mul_f32 v156, v164, v156
    v_mul_f32 v157, v165, v157
    v_mfma_f32_16x16x32_bf16 v[196:199], v[36:39], v[72:75], v[196:199]
    v_add_f32 v216, 1.0, v216
    v_add_f32 v217, 1.0, v217
    v_rcp_f32 v214, v214
    v_rcp_f32 v215, v215
    v_mul_f32 v130, v210, v130
    v_mul_f32 v131, v211, v131
    v_mfma_f32_16x16x32_bf16 v[200:203], v[40:43], v[72:75], v[200:203]
    v_cvt_pk_bf16_f32 v134, v128, v129
    v_mul_f32 v226, s60, v162
    v_mul_f32 v227, s60, v163
    v_exp_f32 v222, v222
    v_exp_f32 v223, v223
    v_mul_f32 v158, v166, v158
    v_mul_f32 v159, v167, v159
    v_pk_add_f32 v[218:219], v[218:219], 1.0 op_sel_hi:[1,0]
    v_rcp_f32 v216, v216
    v_rcp_f32 v217, v217
    v_pk_mul_f32 v[140:141], v[140:141], v[212:213]
    v_cvt_pk_bf16_f32 v135, v130, v131
    buffer_store_dwordx4 v[132:135], v237, s[56:59], s63 offen offset:3072 sc1
    v_pk_mul_f32 v[204:205], v[172:173], s[60:61]
    v_exp_f32 v224, v224
    v_exp_f32 v225, v225
    v_pk_mul_f32 v[160:161], v[160:161], v[168:169]
    v_pk_add_f32 v[220:221], v[220:221], 1.0 op_sel_hi:[1,0]
    v_rcp_f32 v218, v218
    v_rcp_f32 v219, v219
    v_pk_mul_f32 v[142:143], v[142:143], v[214:215]
    v_cvt_pk_bf16_f32 v148, v140, v141
    v_pk_mul_f32 v[206:207], v[174:175], s[60:61]
    v_exp_f32 v226, v226
    v_exp_f32 v227, v227
    v_pk_mul_f32 v[162:163], v[162:163], v[170:171]
    v_pk_add_f32 v[222:223], v[222:223], 1.0 op_sel_hi:[1,0]
    v_rcp_f32 v220, v220
    v_rcp_f32 v221, v221
    v_pk_mul_f32 v[144:145], v[144:145], v[216:217]
    v_cvt_pk_bf16_f32 v149, v142, v143
    v_pk_mul_f32 v[208:209], v[176:177], s[60:61]
    v_exp_f32 v204, v204
    v_exp_f32 v205, v205
    v_pk_mul_f32 v[172:173], v[172:173], v[180:181]
    v_pk_add_f32 v[224:225], v[224:225], 1.0 op_sel_hi:[1,0]
    v_rcp_f32 v222, v222
    v_rcp_f32 v223, v223
    v_pk_mul_f32 v[146:147], v[146:147], v[218:219]
    v_cvt_pk_bf16_f32 v150, v144, v145
    v_pk_mul_f32 v[210:211], v[178:179], s[60:61]
    v_exp_f32 v206, v206
    v_exp_f32 v207, v207
    v_pk_mul_f32 v[174:175], v[174:175], v[182:183]
    v_pk_add_f32 v[226:227], v[226:227], 1.0 op_sel_hi:[1,0]
    v_rcp_f32 v224, v224
    v_rcp_f32 v225, v225
    v_pk_mul_f32 v[156:157], v[156:157], v[220:221]
    v_cvt_pk_bf16_f32 v151, v146, v147
    buffer_store_dwordx4 v[148:151], v11, s[56:59], s63 offen offset:0 sc1
    v_pk_mul_f32 v[212:213], v[188:189], s[60:61]
    v_exp_f32 v208, v208
    v_exp_f32 v209, v209
    v_pk_mul_f32 v[176:177], v[176:177], v[184:185]
    v_pk_add_f32 v[204:205], v[204:205], 1.0 op_sel_hi:[1,0]
    v_rcp_f32 v226, v226
    v_rcp_f32 v227, v227
    v_pk_mul_f32 v[158:159], v[158:159], v[222:223]
    v_cvt_pk_bf16_f32 v164, v156, v157
    v_pk_mul_f32 v[214:215], v[190:191], s[60:61]
    v_exp_f32 v210, v210
    v_exp_f32 v211, v211
    v_pk_mul_f32 v[178:179], v[178:179], v[186:187]
    v_pk_add_f32 v[206:207], v[206:207], 1.0 op_sel_hi:[1,0]
    v_rcp_f32 v204, v204
    v_rcp_f32 v205, v205
    v_pk_mul_f32 v[160:161], v[160:161], v[224:225]
    v_cvt_pk_bf16_f32 v165, v158, v159
    v_pk_mul_f32 v[216:217], v[192:193], s[60:61]
    v_exp_f32 v212, v212
    v_exp_f32 v213, v213
    v_pk_mul_f32 v[188:189], v[188:189], v[196:197]
    v_pk_add_f32 v[208:209], v[208:209], 1.0 op_sel_hi:[1,0]
    v_rcp_f32 v206, v206
    v_rcp_f32 v207, v207
    v_pk_mul_f32 v[162:163], v[162:163], v[226:227]
    v_cvt_pk_bf16_f32 v166, v160, v161
    v_pk_mul_f32 v[218:219], v[194:195], s[60:61]
    v_exp_f32 v214, v214
    v_exp_f32 v215, v215
    v_pk_mul_f32 v[190:191], v[190:191], v[198:199]
    v_pk_add_f32 v[210:211], v[210:211], 1.0 op_sel_hi:[1,0]
    v_rcp_f32 v208, v208
    v_rcp_f32 v209, v209
    v_pk_mul_f32 v[172:173], v[172:173], v[204:205]
    v_cvt_pk_bf16_f32 v167, v162, v163
    buffer_store_dwordx4 v[164:167], v11, s[56:59], s63 offen offset:1024 sc1
    v_exp_f32 v216, v216
    v_exp_f32 v217, v217
    v_pk_mul_f32 v[192:193], v[192:193], v[200:201]
    v_pk_add_f32 v[212:213], v[212:213], 1.0 op_sel_hi:[1,0]
    v_rcp_f32 v210, v210
    v_rcp_f32 v211, v211
    v_pk_mul_f32 v[174:175], v[174:175], v[206:207]
    v_cvt_pk_bf16_f32 v180, v172, v173
    v_exp_f32 v218, v218
    v_exp_f32 v219, v219
    v_pk_mul_f32 v[194:195], v[194:195], v[202:203]
    v_pk_add_f32 v[214:215], v[214:215], 1.0 op_sel_hi:[1,0]
    v_rcp_f32 v212, v212
    v_rcp_f32 v213, v213
    v_pk_mul_f32 v[176:177], v[176:177], v[208:209]
    v_cvt_pk_bf16_f32 v181, v174, v175
    v_pk_add_f32 v[216:217], v[216:217], 1.0 op_sel_hi:[1,0]
    v_rcp_f32 v214, v214
    v_rcp_f32 v215, v215
    v_pk_mul_f32 v[178:179], v[178:179], v[210:211]
    v_cvt_pk_bf16_f32 v182, v176, v177
    v_pk_add_f32 v[218:219], v[218:219], 1.0 op_sel_hi:[1,0]
    v_rcp_f32 v216, v216
    v_rcp_f32 v217, v217
    v_pk_mul_f32 v[188:189], v[188:189], v[212:213]
    v_cvt_pk_bf16_f32 v183, v178, v179
    buffer_store_dwordx4 v[180:183], v11, s[56:59], s63 offen offset:2048 sc1
    v_rcp_f32 v218, v218
    v_rcp_f32 v219, v219
    v_pk_mul_f32 v[190:191], v[190:191], v[214:215]
    v_cvt_pk_bf16_f32 v196, v188, v189
    v_pk_mul_f32 v[192:193], v[192:193], v[216:217]
    v_cvt_pk_bf16_f32 v197, v190, v191
    v_pk_mul_f32 v[194:195], v[194:195], v[218:219]
    v_cvt_pk_bf16_f32 v198, v192, v193
    v_cvt_pk_bf16_f32 v199, v194, v195
    buffer_store_dwordx4 v[196:199], v11, s[56:59], s63 offen offset:3072 sc1
    ds_read_b32 v247, v254 offset:20
    v_mov_b64 v[108:109], 0
    v_mov_b64 v[110:111], 0
    v_mov_b64 v[112:113], 0
    v_mov_b64 v[114:115], 0
    v_mov_b64 v[116:117], 0
    v_mov_b64 v[118:119], 0
    v_mov_b64 v[120:121], 0
    v_mov_b64 v[122:123], 0
    v_mov_b64 v[124:125], 0
    v_mov_b64 v[126:127], 0
    v_mov_b64 v[128:129], 0
    v_mov_b64 v[130:131], 0
    v_mov_b64 v[132:133], 0
    v_mov_b64 v[134:135], 0
    v_mov_b64 v[136:137], 0
    v_mov_b64 v[138:139], 0
    s_mov_b32 s11, 0x40000
    s_waitcnt lgkmcnt(0)
    v_cmp_eq_u32 vcc, 4, v247
    s_cbranch_vccz CR_13
    ds_read_b128 v[140:143], v228 offset:0
    ds_read_b128 v[144:147], v228 offset:512
    ds_read_b128 v[148:151], v228 offset:1024
    ds_read_b128 v[152:155], v228 offset:1536
    ds_read_b128 v[156:159], v228 offset:2048
    ds_read_b128 v[160:163], v228 offset:2560
    ds_read_b128 v[164:167], v228 offset:3072
    ds_read_b128 v[168:171], v228 offset:3584
    s_waitcnt vmcnt(0)
    s_mov_b64 exec, 3
    buffer_store_dwordx2 v[250:251], v10, s[12:15], s5 offen sc1
    s_mov_b64 exec, -1
    s_setprio 1
    s_branch K_conv
CR_13:
    s_waitcnt vmcnt(0)
    s_mov_b64 exec, 3
    buffer_store_dwordx2 v[250:251], v10, s[12:15], s5 offen sc1
    s_mov_b64 exec, -1
    s_setprio 1
CR2_15:
    ds_read_b32 v247, v254 offset:20
    s_waitcnt lgkmcnt(0)
    v_cmp_eq_u32 vcc, 4, v247
    s_cbranch_vccnz CRD_14
    s_sleep 2
    s_sub_u32 s11, s11, 1
    s_cbranch_scc0 CR2_15
CRD_14:
    ds_read_b128 v[140:143], v228 offset:0
    ds_read_b128 v[144:147], v228 offset:512
    ds_read_b128 v[148:151], v228 offset:1024
    ds_read_b128 v[152:155], v228 offset:1536
    ds_read_b128 v[156:159], v228 offset:2048
    ds_read_b128 v[160:163], v228 offset:2560
    ds_read_b128 v[164:167], v228 offset:3072
    ds_read_b128 v[168:171], v228 offset:3584
K_conv:
    ds_read2_b32 v[172:173], v232 offset0:128 offset1:129
    ds_read2_b32 v[174:175], v232 offset0:130 offset1:131
    ds_read2_b32 v[176:177], v232 offset0:0 offset1:1
    ds_read2_b32 v[178:179], v232 offset0:2 offset1:3
    ds_read2_b32 v[180:181], v231 offset0:128 offset1:129
    ds_read2_b32 v[182:183], v231 offset0:130 offset1:131
    ds_read2_b32 v[184:185], v231 offset0:0 offset1:1
    ds_read2_b32 v[186:187], v231 offset0:2 offset1:3
    ds_read2_b32 v[188:189], v230 offset0:128 offset1:129
    ds_read2_b32 v[190:191], v230 offset0:130 offset1:131
    ds_read2_b32 v[192:193], v230 offset0:0 offset1:1
    ds_read2_b32 v[194:195], v230 offset0:2 offset1:3
    ds_read2_b32 v[196:197], v229 offset0:128 offset1:129
    ds_read2_b32 v[198:199], v229 offset0:130 offset1:131
    ds_read2_b32 v[200:201], v229 offset0:0 offset1:1
    ds_read2_b32 v[202:203], v229 offset0:2 offset1:3
    s_add_u32 s44, s42, 0x1000000
    s_addc_u32 s45, s43, 0
    s_mov_b32 s46, 0x280000
    s_mov_b32 s47, 0x00020000
    s_lshl_b32 s68, s8, 1
CV_loop:
    s_waitcnt lgkmcnt(0)
    v_mfma_f32_16x16x32_bf16 v[108:111], v[140:143], v[172:175], v[108:111]
    ds_read_b128 v[12:15], v228 offset:64
    v_mfma_f32_16x16x32_bf16 v[112:115], v[140:143], v[176:179], v[112:115]
    ds_read2_b32 v[44:45], v232 offset0:144 offset1:145
    v_mfma_f32_16x16x32_bf16 v[116:119], v[140:143], v[180:183], v[116:119]
    ds_read2_b32 v[46:47], v232 offset0:146 offset1:147
    v_mfma_f32_16x16x32_bf16 v[120:123], v[140:143], v[184:187], v[120:123]
    ds_read_b128 v[16:19], v228 offset:576
    v_mfma_f32_16x16x32_bf16 v[124:127], v[140:143], v[188:191], v[124:127]
    ds_read2_b32 v[48:49], v232 offset0:16 offset1:17
    v_mfma_f32_16x16x32_bf16 v[128:131], v[140:143], v[192:195], v[128:131]
    ds_read2_b32 v[50:51], v232 offset0:18 offset1:19
    v_mfma_f32_16x16x32_bf16 v[132:135], v[140:143], v[196:199], v[132:135]
    ds_read_b128 v[20:23], v228 offset:1088
    v_mfma_f32_16x16x32_bf16 v[136:139], v[140:143], v[200:203], v[136:139]
    ds_read2_b32 v[52:53], v231 offset0:144 offset1:145
    v_mfma_f32_16x16x32_bf16 v[112:115], v[144:147], v[172:175], v[112:115]
    ds_read2_b32 v[54:55], v231 offset0:146 offset1:147
    v_mfma_f32_16x16x32_bf16 v[116:119], v[144:147], v[176:179], v[116:119]
    ds_read_b128 v[24:27], v228 offset:1600
    v_mfma_f32_16x16x32_bf16 v[120:123], v[144:147], v[180:183], v[120:123]
    ds_read2_b32 v[56:57], v231 offset0:16 offset1:17
    v_mfma_f32_16x16x32_bf16 v[124:127], v[144:147], v[184:187], v[124:127]
    ds_read2_b32 v[58:59], v231 offset0:18 offset1:19
    v_mfma_f32_16x16x32_bf16 v[128:131], v[144:147], v[188:191], v[128:131]
    ds_read_b128 v[28:31], v228 offset:2112
    v_mfma_f32_16x16x32_bf16 v[132:135], v[144:147], v[192:195], v[132:135]
    ds_read2_b32 v[60:61], v230 offset0:144 offset1:145
    v_mfma_f32_16x16x32_bf16 v[136:139], v[144:147], v[196:199], v[136:139]
    ds_read2_b32 v[62:63], v230 offset0:146 offset1:147
    v_mfma_f32_16x16x32_bf16 v[116:119], v[148:151], v[172:175], v[116:119]
    ds_read_b128 v[32:35], v228 offset:2624
    v_mfma_f32_16x16x32_bf16 v[120:123], v[148:151], v[176:179], v[120:123]
    ds_read2_b32 v[64:65], v230 offset0:16 offset1:17
    v_mfma_f32_16x16x32_bf16 v[124:127], v[148:151], v[180:183], v[124:127]
    ds_read2_b32 v[66:67], v230 offset0:18 offset1:19
    v_mfma_f32_16x16x32_bf16 v[128:131], v[148:151], v[184:187], v[128:131]
    ds_read_b128 v[36:39], v228 offset:3136
    v_mfma_f32_16x16x32_bf16 v[132:135], v[148:151], v[188:191], v[132:135]
    ds_read2_b32 v[68:69], v229 offset0:144 offset1:145
    v_mfma_f32_16x16x32_bf16 v[136:139], v[148:151], v[192:195], v[136:139]
    ds_read2_b32 v[70:71], v229 offset0:146 offset1:147
    v_mfma_f32_16x16x32_bf16 v[120:123], v[152:155], v[172:175], v[120:123]
    ds_read_b128 v[40:43], v228 offset:3648
    v_mfma_f32_16x16x32_bf16 v[124:127], v[152:155], v[176:179], v[124:127]
    ds_read2_b32 v[72:73], v229 offset0:16 offset1:17
    v_mfma_f32_16x16x32_bf16 v[128:131], v[152:155], v[180:183], v[128:131]
    ds_read2_b32 v[74:75], v229 offset0:18 offset1:19
    v_mfma_f32_16x16x32_bf16 v[132:135], v[152:155], v[184:187], v[132:135]
    v_mfma_f32_16x16x32_bf16 v[136:139], v[152:155], v[188:191], v[136:139]
    v_mfma_f32_16x16x32_bf16 v[124:127], v[156:159], v[172:175], v[124:127]
    v_mfma_f32_16x16x32_bf16 v[128:131], v[156:159], v[176:179], v[128:131]
    v_mfma_f32_16x16x32_bf16 v[132:135], v[156:159], v[180:183], v[132:135]
    v_mfma_f32_16x16x32_bf16 v[136:139], v[156:159], v[184:187], v[136:139]
    v_mfma_f32_16x16x32_bf16 v[128:131], v[160:163], v[172:175], v[128:131]
    v_mfma_f32_16x16x32_bf16 v[136:139], v[160:163], v[180:183], v[136:139]
    v_mfma_f32_16x16x32_bf16 v[132:135], v[160:163], v[176:179], v[132:135]
    v_mfma_f32_16x16x32_bf16 v[136:139], v[164:167], v[176:179], v[136:139]
    v_mfma_f32_16x16x32_bf16 v[132:135], v[164:167], v[172:175], v[132:135]
    v_mfma_f32_16x16x32_bf16 v[136:139], v[168:171], v[172:175], v[136:139]
    s_waitcnt lgkmcnt(0)
    v_mfma_f32_16x16x32_bf16 v[108:111], v[12:15], v[44:47], v[108:111]
    ds_read_b128 v[140:143], v228 offset:128
    v_mfma_f32_16x16x32_bf16 v[112:115], v[12:15], v[48:51], v[112:115]
    ds_read2_b32 v[172:173], v232 offset0:160 offset1:161
    v_mfma_f32_16x16x32_bf16 v[116:119], v[12:15], v[52:55], v[116:119]
    ds_read2_b32 v[174:175], v232 offset0:162 offset1:163
    v_mfma_f32_16x16x32_bf16 v[120:123], v[12:15], v[56:59], v[120:123]
    ds_read_b128 v[144:147], v228 offset:640
    v_mfma_f32_16x16x32_bf16 v[124:127], v[12:15], v[60:63], v[124:127]
    ds_read2_b32 v[176:177], v232 offset0:32 offset1:33
    v_mfma_f32_16x16x32_bf16 v[128:131], v[12:15], v[64:67], v[128:131]
    ds_read2_b32 v[178:179], v232 offset0:34 offset1:35
    v_mfma_f32_16x16x32_bf16 v[132:135], v[12:15], v[68:71], v[132:135]
    ds_read_b128 v[148:151], v228 offset:1152
    v_mfma_f32_16x16x32_bf16 v[136:139], v[12:15], v[72:75], v[136:139]
    ds_read2_b32 v[180:181], v231 offset0:160 offset1:161
    v_mfma_f32_16x16x32_bf16 v[112:115], v[16:19], v[44:47], v[112:115]
    ds_read2_b32 v[182:183], v231 offset0:162 offset1:163
    v_mfma_f32_16x16x32_bf16 v[116:119], v[16:19], v[48:51], v[116:119]
    ds_read_b128 v[152:155], v228 offset:1664
    v_mfma_f32_16x16x32_bf16 v[120:123], v[16:19], v[52:55], v[120:123]
    ds_read2_b32 v[184:185], v231 offset0:32 offset1:33
    v_mfma_f32_16x16x32_bf16 v[124:127], v[16:19], v[56:59], v[124:127]
    ds_read2_b32 v[186:187], v231 offset0:34 offset1:35
    v_mfma_f32_16x16x32_bf16 v[128:131], v[16:19], v[60:63], v[128:131]
    ds_read_b128 v[156:159], v228 offset:2176
    v_mfma_f32_16x16x32_bf16 v[132:135], v[16:19], v[64:67], v[132:135]
    ds_read2_b32 v[188:189], v230 offset0:160 offset1:161
    v_mfma_f32_16x16x32_bf16 v[136:139], v[16:19], v[68:71], v[136:139]
    ds_read2_b32 v[190:191], v230 offset0:162 offset1:163
    v_mfma_f32_16x16x32_bf16 v[116:119], v[20:23], v[44:47], v[116:119]
    ds_read_b128 v[160:163], v228 offset:2688
    v_mfma_f32_16x16x32_bf16 v[120:123], v[20:23], v[48:51], v[120:123]
    ds_read2_b32 v[192:193], v230 offset0:32 offset1:33
    v_mfma_f32_16x16x32_bf16 v[124:127], v[20:23], v[52:55], v[124:127]
    ds_read2_b32 v[194:195], v230 offset0:34 offset1:35
    v_mfma_f32_16x16x32_bf16 v[128:131], v[20:23], v[56:59], v[128:131]
    ds_read_b128 v[164:167], v228 offset:3200
    v_mfma_f32_16x16x32_bf16 v[132:135], v[20:23], v[60:63], v[132:135]
    ds_read2_b32 v[196:197], v229 offset0:160 offset1:161
    v_mfma_f32_16x16x32_bf16 v[136:139], v[20:23], v[64:67], v[136:139]
    ds_read2_b32 v[198:199], v229 offset0:162 offset1:163
    v_mfma_f32_16x16x32_bf16 v[120:123], v[24:27], v[44:47], v[120:123]
    ds_read_b128 v[168:171], v228 offset:3712
    v_mfma_f32_16x16x32_bf16 v[124:127], v[24:27], v[48:51], v[124:127]
    ds_read2_b32 v[200:201], v229 offset0:32 offset1:33
    v_mfma_f32_16x16x32_bf16 v[128:131], v[24:27], v[52:55], v[128:131]
    ds_read2_b32 v[202:203], v229 offset0:34 offset1:35
    v_mfma_f32_16x16x32_bf16 v[132:135], v[24:27], v[56:59], v[132:135]
    v_mfma_f32_16x16x32_bf16 v[136:139], v[24:27], v[60:63], v[136:139]
    v_mfma_f32_16x16x32_bf16 v[124:127], v[28:31], v[44:47], v[124:127]
    v_add_u32 v228, 128, v228
    v_mfma_f32_16x16x32_bf16 v[128:131], v[28:31], v[48:51], v[128:131]
    v_add_u32 v229, 128, v229
    v_mfma_f32_16x16x32_bf16 v[132:135], v[28:31], v[52:55], v[132:135]
    v_add_u32 v230, 128, v230
    v_mfma_f32_16x16x32_bf16 v[136:139], v[28:31], v[56:59], v[136:139]
    v_add_u32 v231, 128, v231
    v_mfma_f32_16x16x32_bf16 v[128:131], v[32:35], v[44:47], v[128:131]
    v_add_u32 v232, 128, v232
    v_mfma_f32_16x16x32_bf16 v[136:139], v[32:35], v[52:55], v[136:139]
    v_mfma_f32_16x16x32_bf16 v[132:135], v[32:35], v[48:51], v[132:135]
    v_mfma_f32_16x16x32_bf16 v[136:139], v[36:39], v[48:51], v[136:139]
    v_mfma_f32_16x16x32_bf16 v[132:135], v[36:39], v[44:47], v[132:135]
    v_mfma_f32_16x16x32_bf16 v[136:139], v[40:43], v[44:47], v[136:139]
    s_sub_u32 s68, s68, 1
    s_cbranch_scc0 CV_loop
    s_waitcnt lgkmcnt(0)
    v_mfma_f32_16x16x32_bf16 v[108:111], v[140:143], v[172:175], v[108:111]
    ds_read_b128 v[12:15], v228 offset:64
    v_mfma_f32_16x16x32_bf16 v[112:115], v[140:143], v[176:179], v[112:115]
    ds_read2_b32 v[44:45], v232 offset0:144 offset1:145
    v_mfma_f32_16x16x32_bf16 v[116:119], v[140:143], v[180:183], v[116:119]
    ds_read2_b32 v[46:47], v232 offset0:146 offset1:147
    v_mfma_f32_16x16x32_bf16 v[120:123], v[140:143], v[184:187], v[120:123]
    ds_read_b128 v[16:19], v228 offset:576
    v_mfma_f32_16x16x32_bf16 v[124:127], v[140:143], v[188:191], v[124:127]
    ds_read2_b32 v[48:49], v232 offset0:16 offset1:17
    v_mfma_f32_16x16x32_bf16 v[128:131], v[140:143], v[192:195], v[128:131]
    ds_read2_b32 v[50:51], v232 offset0:18 offset1:19
    v_mfma_f32_16x16x32_bf16 v[132:135], v[140:143], v[196:199], v[132:135]
    ds_read_b128 v[20:23], v228 offset:1088
    v_mfma_f32_16x16x32_bf16 v[136:139], v[140:143], v[200:203], v[136:139]
    ds_read2_b32 v[52:53], v231 offset0:144 offset1:145
    v_mfma_f32_16x16x32_bf16 v[112:115], v[144:147], v[172:175], v[112:115]
    ds_read2_b32 v[54:55], v231 offset0:146 offset1:147
    v_mfma_f32_16x16x32_bf16 v[116:119], v[144:147], v[176:179], v[116:119]
    ds_read_b128 v[24:27], v228 offset:1600
    v_mfma_f32_16x16x32_bf16 v[120:123], v[144:147], v[180:183], v[120:123]
    ds_read2_b32 v[56:57], v231 offset0:16 offset1:17
    v_mfma_f32_16x16x32_bf16 v[124:127], v[144:147], v[184:187], v[124:127]
    ds_read2_b32 v[58:59], v231 offset0:18 offset1:19
    v_mfma_f32_16x16x32_bf16 v[128:131], v[144:147], v[188:191], v[128:131]
    ds_read_b128 v[28:31], v228 offset:2112
    v_mfma_f32_16x16x32_bf16 v[132:135], v[144:147], v[192:195], v[132:135]
    ds_read2_b32 v[60:61], v230 offset0:144 offset1:145
    v_mfma_f32_16x16x32_bf16 v[136:139], v[144:147], v[196:199], v[136:139]
    ds_read2_b32 v[62:63], v230 offset0:146 offset1:147
    v_mfma_f32_16x16x32_bf16 v[116:119], v[148:151], v[172:175], v[116:119]
    ds_read_b128 v[32:35], v228 offset:2624
    v_mfma_f32_16x16x32_bf16 v[120:123], v[148:151], v[176:179], v[120:123]
    ds_read2_b32 v[64:65], v230 offset0:16 offset1:17
    v_mfma_f32_16x16x32_bf16 v[124:127], v[148:151], v[180:183], v[124:127]
    ds_read2_b32 v[66:67], v230 offset0:18 offset1:19
    v_mfma_f32_16x16x32_bf16 v[128:131], v[148:151], v[184:187], v[128:131]
    ds_read_b128 v[36:39], v228 offset:3136
    v_mfma_f32_16x16x32_bf16 v[132:135], v[148:151], v[188:191], v[132:135]
    ds_read2_b32 v[68:69], v229 offset0:144 offset1:145
    v_mfma_f32_16x16x32_bf16 v[136:139], v[148:151], v[192:195], v[136:139]
    ds_read2_b32 v[70:71], v229 offset0:146 offset1:147
    v_mfma_f32_16x16x32_bf16 v[120:123], v[152:155], v[172:175], v[120:123]
    ds_read_b128 v[40:43], v228 offset:3648
    v_mfma_f32_16x16x32_bf16 v[124:127], v[152:155], v[176:179], v[124:127]
    ds_read2_b32 v[72:73], v229 offset0:16 offset1:17
    v_mfma_f32_16x16x32_bf16 v[128:131], v[152:155], v[180:183], v[128:131]
    ds_read2_b32 v[74:75], v229 offset0:18 offset1:19
    v_mfma_f32_16x16x32_bf16 v[132:135], v[152:155], v[184:187], v[132:135]
    v_mfma_f32_16x16x32_bf16 v[136:139], v[152:155], v[188:191], v[136:139]
    v_mfma_f32_16x16x32_bf16 v[124:127], v[156:159], v[172:175], v[124:127]
    v_mfma_f32_16x16x32_bf16 v[128:131], v[156:159], v[176:179], v[128:131]
    v_mfma_f32_16x16x32_bf16 v[132:135], v[156:159], v[180:183], v[132:135]
    v_mfma_f32_16x16x32_bf16 v[136:139], v[156:159], v[184:187], v[136:139]
    v_mfma_f32_16x16x32_bf16 v[128:131], v[160:163], v[172:175], v[128:131]
    v_mfma_f32_16x16x32_bf16 v[136:139], v[160:163], v[180:183], v[136:139]
    v_mfma_f32_16x16x32_bf16 v[132:135], v[160:163], v[176:179], v[132:135]
    v_mfma_f32_16x16x32_bf16 v[136:139], v[164:167], v[176:179], v[136:139]
    v_mfma_f32_16x16x32_bf16 v[132:135], v[164:167], v[172:175], v[132:135]
    v_mfma_f32_16x16x32_bf16 v[136:139], v[168:171], v[172:175], v[136:139]
    s_waitcnt lgkmcnt(0)
    v_mfma_f32_16x16x32_bf16 v[108:111], v[12:15], v[44:47], v[108:111]
    v_mfma_f32_16x16x32_bf16 v[112:115], v[12:15], v[48:51], v[112:115]
    v_mfma_f32_16x16x32_bf16 v[116:119], v[12:15], v[52:55], v[116:119]
    v_mfma_f32_16x16x32_bf16 v[120:123], v[12:15], v[56:59], v[120:123]
    v_mfma_f32_16x16x32_bf16 v[124:127], v[12:15], v[60:63], v[124:127]
    v_mfma_f32_16x16x32_bf16 v[128:131], v[12:15], v[64:67], v[128:131]
    v_mfma_f32_16x16x32_bf16 v[132:135], v[12:15], v[68:71], v[132:135]
    v_mfma_f32_16x16x32_bf16 v[136:139], v[12:15], v[72:75], v[136:139]
    v_mfma_f32_16x16x32_bf16 v[112:115], v[16:19], v[44:47], v[112:115]
    v_mfma_f32_16x16x32_bf16 v[116:119], v[16:19], v[48:51], v[116:119]
    ds_write_b128 v234, v[108:111] offset:0
    v_mfma_f32_16x16x32_bf16 v[120:123], v[16:19], v[52:55], v[120:123]
    v_mfma_f32_16x16x32_bf16 v[124:127], v[16:19], v[56:59], v[124:127]
    v_mfma_f32_16x16x32_bf16 v[128:131], v[16:19], v[60:63], v[128:131]
    v_mfma_f32_16x16x32_bf16 v[132:135], v[16:19], v[64:67], v[132:135]
    v_mfma_f32_16x16x32_bf16 v[136:139], v[16:19], v[68:71], v[136:139]
    v_mfma_f32_16x16x32_bf16 v[116:119], v[20:23], v[44:47], v[116:119]
    v_mfma_f32_16x16x32_bf16 v[120:123], v[20:23], v[48:51], v[120:123]
    v_mfma_f32_16x16x32_bf16 v[124:127], v[20:23], v[52:55], v[124:127]
    ds_write_b128 v234, v[112:115] offset:1024
    v_mfma_f32_16x16x32_bf16 v[128:131], v[20:23], v[56:59], v[128:131]
    v_mfma_f32_16x16x32_bf16 v[132:135], v[20:23], v[60:63], v[132:135]
    v_mfma_f32_16x16x32_bf16 v[136:139], v[20:23], v[64:67], v[136:139]
    v_mfma_f32_16x16x32_bf16 v[120:123], v[24:27], v[44:47], v[120:123]
    v_mfma_f32_16x16x32_bf16 v[124:127], v[24:27], v[48:51], v[124:127]
    v_mfma_f32_16x16x32_bf16 v[128:131], v[24:27], v[52:55], v[128:131]
    v_mfma_f32_16x16x32_bf16 v[132:135], v[24:27], v[56:59], v[132:135]
    ds_write_b128 v234, v[116:119] offset:2048
    v_mfma_f32_16x16x32_bf16 v[136:139], v[24:27], v[60:63], v[136:139]
    v_mfma_f32_16x16x32_bf16 v[124:127], v[28:31], v[44:47], v[124:127]
    v_mfma_f32_16x16x32_bf16 v[128:131], v[28:31], v[48:51], v[128:131]
    v_mfma_f32_16x16x32_bf16 v[132:135], v[28:31], v[52:55], v[132:135]
    v_mfma_f32_16x16x32_bf16 v[136:139], v[28:31], v[56:59], v[136:139]
    v_mfma_f32_16x16x32_bf16 v[128:131], v[32:35], v[44:47], v[128:131]
    ds_write_b128 v234, v[120:123] offset:3072
    v_mfma_f32_16x16x32_bf16 v[136:139], v[32:35], v[52:55], v[136:139]
    v_mfma_f32_16x16x32_bf16 v[132:135], v[32:35], v[48:51], v[132:135]
    v_mfma_f32_16x16x32_bf16 v[136:139], v[36:39], v[48:51], v[136:139]
    v_mfma_f32_16x16x32_bf16 v[132:135], v[36:39], v[44:47], v[132:135]
    v_mfma_f32_16x16x32_bf16 v[136:139], v[40:43], v[44:47], v[136:139]
    ds_write_b128 v234, v[124:127] offset:4096
    s_lshl_b32 s48, s18, 16
    s_and_b32 s49, s18, 0xffff0000
    s_lshl_b32 s50, s19, 16
    s_and_b32 s51, s19, 0xffff0000
    s_nop 4
    ds_write_b128 v234, v[128:131] offset:5120
    ds_write_b128 v234, v[132:135] offset:6144
    ds_write_b128 v234, v[136:139] offset:7168
    s_waitcnt lgkmcnt(0)
    s_mov_b64 exec, 1
    ds_add_u32 v255, v253
    s_mov_b64 exec, -1
    s_add_u32 s71, s71, 4
    s_mov_b32 s11, 0x40000
CS_16:
    ds_read_b32 v247, v255
    s_waitcnt lgkmcnt(0)
    v_cmp_le_u32 vcc, s71, v247
    s_cbranch_vccnz CSD_17
    s_sub_u32 s11, s11, 1
    s_cbranch_scc0 CS_16
CSD_17:
    s_mov_b32 s11, 0xffff0000
    s_cmp_eq_u32 s8, 1
    s_cbranch_scc1 CV_epiB
    ds_read_b128 v[12:15], v235 offset:0
    ds_read_b128 v[16:19], v235 offset:8192
    ds_read_b128 v[20:23], v235 offset:1024
    ds_read_b128 v[24:27], v235 offset:9216
    ds_read_b128 v[28:31], v235 offset:16384
    ds_read_b128 v[32:35], v235 offset:24576
    ds_read_b128 v[36:39], v235 offset:17408
    ds_read_b128 v[40:43], v235 offset:25600
    ds_read_b32 v48, v233 offset:576
    ds_read_b32 v49, v233 offset:512
    ds_read_b32 v50, v233 offset:64
    ds_read_b32 v51, v233 offset:0
    ds_read_b32 v52, v233 offset:14400
    ds_read_b32 v53, v233 offset:14336
    ds_read_b32 v54, v233 offset:13888
    ds_read_b32 v55, v233 offset:13824
    s_waitcnt lgkmcnt(8)
    v_add_f32 v12, v12, v16
    v_add_f32 v13, v13, v17
    v_add_f32 v14, v14, v18
    v_add_f32 v15, v15, v19
    v_add_f32 v20, v20, v24
    v_add_f32 v21, v21, v25
    v_add_f32 v22, v22, v26
    v_add_f32 v23, v23, v27
    v_add_f32 v28, v28, v32
    v_add_f32 v29, v29, v33
    v_add_f32 v30, v30, v34
    v_add_f32 v31, v31, v35
    v_add_f32 v36, v36, v40
    v_add_f32 v37, v37, v41
    v_add_f32 v38, v38, v42
    v_add_f32 v39, v39, v43
    s_waitcnt lgkmcnt(0)
    s_mov_b64 exec, 1
    ds_add_u32 v255, v253
    s_mov_b64 exec, -1
    s_add_u32 s71, s71, 4
    v_and_b32 v68, s11, v48
    v_lshlrev_b32 v48, 16, v48
    v_fmac_f32 v12, s48, v68
    v_fmac_f32 v13, s48, v48
    v_and_b32 v69, s11, v52
    v_lshlrev_b32 v52, 16, v52
    v_fmac_f32 v28, s49, v69
    v_fmac_f32 v29, s49, v52
    v_cvt_pk_bf16_f32 v72, v12, v28
    v_cvt_pk_bf16_f32 v73, v13, v29
    v_and_b32 v68, s11, v49
    v_lshlrev_b32 v49, 16, v49
    v_fmac_f32 v14, s48, v68
    v_fmac_f32 v15, s48, v49
    v_and_b32 v69, s11, v53
    v_lshlrev_b32 v53, 16, v53
    v_fmac_f32 v30, s49, v69
    v_fmac_f32 v31, s49, v53
    v_cvt_pk_bf16_f32 v74, v14, v30
    v_cvt_pk_bf16_f32 v75, v15, v31
    buffer_store_dwordx4 v[72:75], v237, s[44:47], s66 offen offset:0 sc1
    v_and_b32 v68, s11, v50
    v_lshlrev_b32 v50, 16, v50
    v_fmac_f32 v20, s48, v68
    v_fmac_f32 v21, s48, v50
    v_and_b32 v69, s11, v54
    v_lshlrev_b32 v54, 16, v54
    v_fmac_f32 v36, s49, v69
    v_fmac_f32 v37, s49, v54
    v_cvt_pk_bf16_f32 v76, v20, v36
    v_cvt_pk_bf16_f32 v77, v21, v37
    v_and_b32 v68, s11, v51
    v_lshlrev_b32 v51, 16, v51
    v_fmac_f32 v22, s48, v68
    v_fmac_f32 v23, s48, v51
    v_and_b32 v69, s11, v55
    v_lshlrev_b32 v55, 16, v55
    v_fmac_f32 v38, s49, v69
    v_fmac_f32 v39, s49, v55
    v_cvt_pk_bf16_f32 v78, v22, v38
    v_cvt_pk_bf16_f32 v79, v23, v39
    buffer_store_dwordx4 v[76:79], v237, s[44:47], s66 offen offset:1024 sc1
    s_cmp_lt_u32 s10, 4
    s_cbranch_scc1 K_prep_g2b
    s_waitcnt vmcnt(0)
    s_mov_b64 exec, 1
    buffer_store_dwordx2 v[250:251], v252, s[12:15], s6 offen sc1
    s_mov_b64 exec, -1
    s_branch K_aterm
CV_epiB:
    ds_read_b128 v[12:15], v235 offset:0
    ds_read_b128 v[16:19], v235 offset:1024
    ds_read_b128 v[20:23], v235 offset:13824
    ds_read_b128 v[24:27], v235 offset:14848
    ds_read_b128 v[28:31], v235 offset:27648
    ds_read_b128 v[32:35], v235 offset:28672
    ds_read_b128 v[36:39], v235 offset:41472
    ds_read_b128 v[40:43], v235 offset:42496
    ds_read_b32 v48, v233 offset:576
    ds_read_b32 v49, v233 offset:512
    ds_read_b32 v50, v233 offset:64
    ds_read_b32 v51, v233 offset:0
    ds_read_b32 v52, v233 offset:14400
    ds_read_b32 v53, v233 offset:14336
    ds_read_b32 v54, v233 offset:13888
    ds_read_b32 v55, v233 offset:13824
    ds_read_b32 v56, v233 offset:28224
    ds_read_b32 v57, v233 offset:28160
    ds_read_b32 v58, v233 offset:27712
    ds_read_b32 v59, v233 offset:27648
    ds_read_b32 v60, v233 offset:42048
    ds_read_b32 v61, v233 offset:41984
    ds_read_b32 v62, v233 offset:41536
    ds_read_b32 v63, v233 offset:41472
    v_lshlrev_b32 v247, 3, v1
    s_waitcnt lgkmcnt(0)
    s_mov_b64 exec, 1
    ds_add_u32 v255, v253
    s_mov_b64 exec, -1
    s_add_u32 s71, s71, 4
    v_and_b32 v68, s11, v48
    v_lshlrev_b32 v48, 16, v48
    v_fmac_f32 v12, s48, v68
    v_fmac_f32 v13, s48, v48
    v_and_b32 v69, s11, v52
    v_lshlrev_b32 v52, 16, v52
    v_fmac_f32 v20, s49, v69
    v_fmac_f32 v21, s49, v52
    v_cvt_pk_bf16_f32 v72, v12, v20
    v_cvt_pk_bf16_f32 v73, v13, v21
    v_and_b32 v68, s11, v49
    v_lshlrev_b32 v49, 16, v49
    v_fmac_f32 v14, s48, v68
    v_fmac_f32 v15, s48, v49
    v_and_b32 v69, s11, v53
    v_lshlrev_b32 v53, 16, v53
    v_fmac_f32 v22, s49, v69
    v_fmac_f32 v23, s49, v53
    v_cvt_pk_bf16_f32 v74, v14, v22
    v_cvt_pk_bf16_f32 v75, v15, v23
    buffer_store_dwordx4 v[72:75], v237, s[44:47], s66 offen offset:0 sc1
    v_and_b32 v68, s11, v50
    v_lshlrev_b32 v50, 16, v50
    v_fmac_f32 v16, s48, v68
    v_fmac_f32 v17, s48, v50
    v_and_b32 v69, s11, v54
    v_lshlrev_b32 v54, 16, v54
    v_fmac_f32 v24, s49, v69
    v_fmac_f32 v25, s49, v54
    v_cvt_pk_bf16_f32 v76, v16, v24
    v_cvt_pk_bf16_f32 v77, v17, v25
    v_and_b32 v68, s11, v51
    v_lshlrev_b32 v51, 16, v51
    v_fmac_f32 v18, s48, v68
    v_fmac_f32 v19, s48, v51
    v_and_b32 v69, s11, v55
    v_lshlrev_b32 v55, 16, v55
    v_fmac_f32 v26, s49, v69
    v_fmac_f32 v27, s49, v55
    v_cvt_pk_bf16_f32 v78, v18, v26
    v_cvt_pk_bf16_f32 v79, v19, v27
    buffer_store_dwordx4 v[76:79], v237, s[44:47], s66 offen offset:1024 sc1
    v_and_b32 v68, s11, v56
    v_lshlrev_b32 v56, 16, v56
    v_fmac_f32 v28, s50, v68
    v_fmac_f32 v29, s50, v56
    v_and_b32 v69, s11, v60
    v_lshlrev_b32 v60, 16, v60
    v_fmac_f32 v36, s51, v69
    v_fmac_f32 v37, s51, v60
    v_cvt_pk_bf16_f32 v80, v28, v36
    v_cvt_pk_bf16_f32 v81, v29, v37
    v_and_b32 v68, s11, v57
    v_lshlrev_b32 v57, 16, v57
    v_fmac_f32 v30, s50, v68
    v_fmac_f32 v31, s50, v57
    v_and_b32 v69, s11, v61
    v_lshlrev_b32 v61, 16, v61
    v_fmac_f32 v38, s51, v69
    v_fmac_f32 v39, s51, v61
    v_cvt_pk_bf16_f32 v82, v30, v38
    v_cvt_pk_bf16_f32 v83, v31, v39
    s_add_u32 s66, s66, 8192
    buffer_store_dwordx4 v[80:83], v237, s[44:47], s66 offen offset:0 sc1
    v_and_b32 v68, s11, v58
    v_lshlrev_b32 v58, 16, v58
    v_fmac_f32 v32, s50, v68
    v_fmac_f32 v33, s50, v58
    v_and_b32 v69, s11, v62
    v_lshlrev_b32 v62, 16, v62
    v_fmac_f32 v40, s51, v69
    v_fmac_f32 v41, s51, v62
    v_cvt_pk_bf16_f32 v84, v32, v40
    v_cvt_pk_bf16_f32 v85, v33, v41
    v_and_b32 v68, s11, v59
    v_lshlrev_b32 v59, 16, v59
    v_fmac_f32 v34, s50, v68
    v_fmac_f32 v35, s50, v59
    v_and_b32 v69, s11, v63
    v_lshlrev_b32 v63, 16, v63
    v_fmac_f32 v42, s51, v69
    v_fmac_f32 v43, s51, v63
    v_cvt_pk_bf16_f32 v86, v34, v42
    v_cvt_pk_bf16_f32 v87, v35, v43
    buffer_store_dwordx4 v[84:87], v237, s[44:47], s66 offen offset:1024 sc1
    s_waitcnt vmcnt(0)
    s_mov_b64 exec, 3
    buffer_store_dwordx2 v[250:251], v247, s[12:15], s6 offen sc1
    s_mov_b64 exec, -1
K_aterm:
    s_setprio 3
    s_lshl_b32 s65, s3, 2
    s_lshr_b32 s66, s4, 3
    s_add_u32 s65, s65, s66
    s_and_b32 s66, s4, 7
    s_mov_b32 s52, s16
    s_mov_b32 s53, s17
    s_mov_b32 s54, 0x280000
    s_mov_b32 s55, 0x00020000
    s_lshl_b32 s67, s65, 6
    s_lshl_b32 s68, s9, 4
    s_add_u32 s67, s67, s68
    v_and_b32 v8, 15, v1
    v_add_u32 v8, s67, v8
    v_lshrrev_b32 v9, 4, v1
    s_mul_i32 s67, s67, 1280
    s_mul_i32 s68, s66, 160
    s_add_u32 s67, s67, s68
    v_add_u32 v10, 0, v1
    v_mul_u32_u24 v12, 205, v10
    v_lshrrev_b32 v12, 11, v12
    v_mul_u32_u24 v12, 1120, v12
    v_lshl_add_u32 v12, v10, 4, v12
    v_add_u32 v12, s67, v12
    v_add_u32 v10, 64, v1
    v_mul_u32_u24 v13, 205, v10
    v_lshrrev_b32 v13, 11, v13
    v_mul_u32_u24 v13, 1120, v13
    v_lshl_add_u32 v13, v10, 4, v13
    v_add_u32 v13, s67, v13
    v_add_u32 v10, 128, v1
    v_mul_u32_u24 v14, 205, v10
    v_lshrrev_b32 v14, 11, v14
    v_mul_u32_u24 v14, 1120, v14
    v_lshl_add_u32 v14, v10, 4, v14
    v_add_u32 v14, s67, v14
    v_lshrrev_b32 v10, 5, v1
    v_lshl_add_u32 v14, v10, 30, v14
    s_lshl_b32 s68, s9, 12
    s_add_u32 s68, s68, 135168
    s_mov_b32 s11, 0x40000
CS_18:
    ds_read_b32 v247, v255
    s_waitcnt lgkmcnt(0)
    v_cmp_le_u32 vcc, s71, v247
    s_cbranch_vccnz CSD_19
    s_sub_u32 s11, s11, 1
    s_cbranch_scc0 CS_18
CSD_19:
    s_add_u32 m0, s68, 0
    s_nop 0
    buffer_load_dwordx4 v12, s[52:55], 0 offen lds
    s_add_u32 m0, s68, 1024
    s_nop 0
    buffer_load_dwordx4 v13, s[52:55], 0 offen lds
    s_add_u32 m0, s68, 2048
    s_nop 0
    buffer_load_dwordx4 v14, s[52:55], 0 offen lds
    v_and_b32 v10, 15, v1
    v_mul_u32_u24 v10, 160, v10
    v_lshl_add_u32 v10, v9, 3, v10
    v_add_u32 v10, s68, v10
    s_lshl_b32 s67, s65, 5
    s_add_u32 s67, s67, s9
    s_add_u32 s67, s67, 27
    s_lshl_b32 s67, s67, 8
    v_and_b32 v25, 1, v1
    v_lshl_add_u32 v25, v25, 7, s67
    buffer_load_dwordx2 v[26:27], v25, s[12:15], 0 offen sc1
    v_lshlrev_b32 v8, 2, v8
    s_add_u32 s60, s42, 0x1400000
    s_addc_u32 s61, s43, 0
    s_mov_b32 s62, 0x2000
    s_mov_b32 s63, 0x00020000
    s_mul_i32 s67, s9, 6144
    s_add_u32 s67, s67, 98304
    v_add_u32 v24, s67, v237
    v_and_b32 v11, 15, v1
    v_lshlrev_b32 v11, 4, v11
    v_lshl_add_u32 v11, v9, 13, v11
    s_waitcnt vmcnt(0)
    s_mov_b32 s68, 0x4000
POLL_20:
    v_cmp_eq_u64 vcc, s[0:1], v[26:27]
    s_cmp_eq_u64 vcc, -1
    s_cbranch_scc1 POLLD_21
    s_sleep 8
    buffer_load_dwordx2 v[26:27], v25, s[12:15], 0 offen sc1
    s_waitcnt vmcnt(0)
    s_sub_u32 s68, s68, 1
    s_cbranch_scc0 POLL_20
POLLD_21:
    buffer_load_dword v8, v8, s[60:63], 0 offen sc1
    ds_read_b64 v[12:13], v10 offset:0
    ds_read_b64 v[14:15], v10 offset:32
    ds_read_b64 v[16:17], v10 offset:64
    ds_read_b64 v[18:19], v10 offset:96
    ds_read_b64 v[20:21], v10 offset:128
    s_lshl_b32 s67, s66, 2
    s_lshr_b32 s68, s65, 3
    s_add_u32 s67, s67, s68
    s_lshl_b32 s67, s67, 6
    s_mul_i32 s68, s9, 10
    s_add_u32 s67, s67, s68
    s_lshl_b32 s67, s67, 3
    s_add_u32 s67, s67, 0x60000
    v_min_u32 v25, 9, v1
    v_lshl_add_u32 v25, v25, 3, s67
    s_mul_i32 s66, s66, 40
    s_add_u32 s66, s66, s68
    s_lshl_b32 s66, s66, 13
    s_lshl_b32 s65, s65, 8
    s_add_u32 s66, s66, s65
    s_lshl_b32 s65, s68, 8
    s_add_u32 s65, s65, 122880
    s_mov_b32 s67, 0xffff0000
    s_waitcnt lgkmcnt(0)
    v_lshlrev_b32 v40, 16, v12
    v_and_b32 v41, s67, v12
    v_lshlrev_b32 v42, 16, v13
    v_and_b32 v43, s67, v13
    v_lshlrev_b32 v44, 16, v14
    v_and_b32 v45, s67, v14
    v_lshlrev_b32 v46, 16, v15
    v_and_b32 v47, s67, v15
    v_lshlrev_b32 v48, 16, v16
    v_and_b32 v49, s67, v16
    v_lshlrev_b32 v50, 16, v17
    v_and_b32 v51, s67, v17
    v_lshlrev_b32 v52, 16, v18
    v_and_b32 v53, s67, v18
    v_lshlrev_b32 v54, 16, v19
    v_and_b32 v55, s67, v19
    v_lshlrev_b32 v56, 16, v20
    v_and_b32 v57, s67, v20
    v_lshlrev_b32 v58, 16, v21
    v_and_b32 v59, s67, v21
    s_waitcnt vmcnt(0)
    v_mov_b32 v9, v8
    v_mul_f32 v40, v8, v40
    v_mul_f32 v41, v8, v41
    v_mul_f32 v42, v8, v42
    v_mul_f32 v43, v8, v43
    v_mul_f32 v44, v8, v44
    v_mul_f32 v45, v8, v45
    v_mul_f32 v46, v8, v46
    v_mul_f32 v47, v8, v47
    v_mul_f32 v48, v8, v48
    v_mul_f32 v49, v8, v49
    v_mul_f32 v50, v8, v50
    v_mul_f32 v51, v8, v51
    v_mul_f32 v52, v8, v52
    v_mul_f32 v53, v8, v53
    v_mul_f32 v54, v8, v54
    v_mul_f32 v55, v8, v55
    v_mul_f32 v56, v8, v56
    v_mul_f32 v57, v8, v57
    v_mul_f32 v58, v8, v58
    v_mul_f32 v59, v8, v59
    v_sub_f32 v8, 1.0, v8
    v_sub_f32 v9, 1.0, v9
    ds_write_b64 v24, v[8:9] offset:5120
    ds_write_b128 v24, v[40:43] offset:0
    ds_write_b128 v24, v[44:47] offset:1024
    ds_write_b128 v24, v[48:51] offset:2048
    ds_write_b128 v24, v[52:55] offset:3072
    ds_write_b128 v24, v[56:59] offset:4096
    s_mov_b32 s11, 0x40000
TW_22:
    ds_read_b32 v247, v254 offset:4
    s_waitcnt lgkmcnt(0)
    v_cmp_eq_u32 vcc, 1, v247
    s_cbranch_vccnz TWD_23
    s_sleep 8
    s_sub_u32 s11, s11, 1
    s_cbranch_scc0 TW_22
TWD_23:
    buffer_load_dwordx2 v[26:27], v25, s[12:15], 0 offen sc1
    s_waitcnt vmcnt(0)
    s_mov_b32 s68, 0x4000
POLL_24:
    v_cmp_eq_u64 vcc, s[0:1], v[26:27]
    s_cmp_eq_u64 vcc, -1
    s_cbranch_scc1 POLLD_25
    s_sleep 16
    buffer_load_dwordx2 v[26:27], v25, s[12:15], 0 offen sc1
    s_waitcnt vmcnt(0)
    s_sub_u32 s68, s68, 1
    s_cbranch_scc0 POLL_24
POLLD_25:
    s_add_u32 m0, s65, 0
    s_nop 0
    buffer_load_dwordx4 v11, s[44:47], s66 offen sc1 lds
    s_add_u32 s66, s66, 32768
    s_add_u32 m0, s65, 1024
    s_nop 0
    buffer_load_dwordx4 v11, s[44:47], s66 offen sc1 lds
    s_add_u32 s66, s66, 32768
    s_add_u32 m0, s65, 2048
    s_mov_b32 exec_hi, 0
    buffer_load_dwordx4 v11, s[44:47], s66 offen sc1 lds
    s_mov_b64 exec, -1
    s_waitcnt vmcnt(0) lgkmcnt(0)
    s_endpgm
K_prep:
    s_mul_i32 s8, s3, 5
    s_add_u32 s8, s8, s4
    s_sub_u32 s8, s8, 27
    s_and_b32 s9, s10, 3
    s_lshl_b32 s65, s8, 2
    s_add_u32 s65, s65, s9
    s_mul_i32 s7, s8, 10
    s_add_u32 s7, s7, s9
    s_add_u32 s7, s7, 6
    s_cmp_lt_u32 s10, 4
    s_cselect_b32 s66, -128, 32
    s_add_u32 s65, s65, s66
    s_mul_i32 s66, s65, 10923
    s_lshr_b32 s66, s66, 16
    s_lshl_b32 s66, s66, 2
    s_add_u32 s66, s66, s65
    s_cmp_lt_i32 s65, 0
    s_cselect_b32 s7, s7, s66
    s_mul_i32 s11, s7, 6554
    s_lshr_b32 s11, s11, 16
    s_mul_i32 s69, s11, 10
    s_sub_u32 s69, s7, s69
    s_lshl_b32 s6, s69, 5
    s_add_u32 s6, s6, s11
    s_lshl_b32 s6, s6, 7
    s_add_u32 s6, s6, 0x40000
    s_lshl_b32 s11, s11, 6
    v_and_b32 v241, 0x38, v1
    v_add_u32 v241, s11, v241
    v_and_b32 v242, 7, v1
    s_lshl_b32 s69, s69, 3
    v_add_u32 v242, s69, v242
    v_mul_u32_u24 v240, 1280, v241
    v_lshl_add_u32 v240, v242, 4, v240
    s_lshl_b32 s64, s69, 15
    s_sub_u32 s11, 1984, s11
    s_lshl_b32 s11, s11, 1
    s_add_u32 s64, s64, s11
    v_subrev_u32 v241, 3840, v240
    v_lshlrev_b32 v242, 6, v242
    s_waitcnt lgkmcnt(0)
    s_barrier
    s_mov_b32 s44, s18
    s_mov_b32 s45, s19
    s_mov_b32 s46, 0x280000
    s_mov_b32 s47, 0x00020000
    s_mov_b32 s48, s20
    s_mov_b32 s49, s21
    s_mov_b32 s50, 0x280000
    s_mov_b32 s51, 0x00020000
    s_mov_b32 s52, s22
    s_mov_b32 s53, s23
    s_mov_b32 s54, 0x1400
    s_mov_b32 s55, 0x00020000
    s_movk_i32 s11, 5120
    buffer_load_dwordx4 v[28:31], v240, s[44:47], 0 offen offset:0
    buffer_load_dwordx4 v[32:35], v240, s[44:47], 0 offen offset:1280
    buffer_load_dwordx4 v[36:39], v240, s[44:47], 0 offen offset:2560
    buffer_load_dwordx4 v[40:43], v240, s[44:47], 0 offen offset:3840
    buffer_load_dwordx4 v[44:47], v240, s[44:47], s11 offen offset:0
    buffer_load_dwordx4 v[48:51], v240, s[44:47], s11 offen offset:1280
    buffer_load_dwordx4 v[52:55], v240, s[44:47], s11 offen offset:2560
    buffer_load_dwordx4 v[56:59], v240, s[44:47], s11 offen offset:3840
    buffer_load_dwordx4 v[16:19], v241, s[44:47], 0 offen offset:0
    buffer_load_dwordx4 v[20:23], v241, s[44:47], 0 offen offset:1280
    buffer_load_dwordx4 v[24:27], v241, s[44:47], 0 offen offset:2560
    buffer_load_dwordx4 v[92:95], v242, s[52:55], 0 offen offset:0
    buffer_load_dwordx4 v[96:99], v242, s[52:55], 0 offen offset:16
    buffer_load_dwordx4 v[100:103], v242, s[52:55], 0 offen offset:32
    buffer_load_dwordx4 v[104:107], v242, s[52:55], 0 offen offset:48
    buffer_load_dwordx4 v[60:63], v240, s[48:51], 0 offen offset:0
    buffer_load_dwordx4 v[64:67], v240, s[48:51], 0 offen offset:1280
    buffer_load_dwordx4 v[68:71], v240, s[48:51], 0 offen offset:2560
    buffer_load_dwordx4 v[72:75], v240, s[48:51], 0 offen offset:3840
    buffer_load_dwordx4 v[76:79], v240, s[48:51], s11 offen offset:0
    buffer_load_dwordx4 v[80:83], v240, s[48:51], s11 offen offset:1280
    buffer_load_dwordx4 v[84:87], v240, s[48:51], s11 offen offset:2560
    buffer_load_dwordx4 v[88:91], v240, s[48:51], s11 offen offset:3840
    s_add_u32 s12, s42, 0x1500000
    s_addc_u32 s13, s43, 0
    s_mov_b32 s14, 0xa0000
    s_mov_b32 s15, 0x00020000
    s_mov_b32 s72, s40
    s_mov_b32 s73, s41
    s_mov_b32 s74, 0x100
    s_mov_b32 s75, 0x00020000
    s_and_b32 s11, s4, 1
    s_lshl_b32 s11, s11, 7
    buffer_load_dwordx2 v[250:251], v252, s[72:75], s11 offen sc1
    s_waitcnt vmcnt(9)
    s_mov_b32 s65, 0xffff0000
    v_lshlrev_b32 v108, 16, v16
    v_and_b32 v109, s65, v16
    v_lshlrev_b32 v110, 16, v20
    v_and_b32 v111, s65, v20
    v_lshlrev_b32 v112, 16, v24
    v_and_b32 v113, s65, v24
    v_lshlrev_b32 v114, 16, v28
    v_and_b32 v115, s65, v28
    v_lshlrev_b32 v116, 16, v32
    v_and_b32 v117, s65, v32
    v_lshlrev_b32 v118, 16, v36
    v_and_b32 v119, s65, v36
    v_lshlrev_b32 v120, 16, v40
    v_and_b32 v121, s65, v40
    v_lshlrev_b32 v122, 16, v44
    v_and_b32 v123, s65, v44
    v_lshlrev_b32 v124, 16, v48
    v_and_b32 v125, s65, v48
    v_lshlrev_b32 v126, 16, v52
    v_and_b32 v127, s65, v52
    v_lshlrev_b32 v128, 16, v56
    v_and_b32 v129, s65, v56
    v_lshlrev_b32 v130, 16, v92
    v_and_b32 v132, s65, v92
    v_lshlrev_b32 v134, 16, v93
    v_and_b32 v136, s65, v93
    v_lshlrev_b32 v131, 16, v94
    v_and_b32 v133, s65, v94
    v_lshlrev_b32 v135, 16, v95
    v_and_b32 v137, s65, v95
    v_pk_mul_f32 v[138:139], v[108:109], v[136:137]
    v_pk_mul_f32 v[140:141], v[110:111], v[136:137]
    v_pk_mul_f32 v[142:143], v[112:113], v[136:137]
    v_pk_mul_f32 v[144:145], v[114:115], v[136:137]
    v_pk_mul_f32 v[146:147], v[116:117], v[136:137]
    v_pk_mul_f32 v[148:149], v[118:119], v[136:137]
    v_pk_mul_f32 v[150:151], v[120:121], v[136:137]
    v_pk_mul_f32 v[152:153], v[122:123], v[136:137]
    v_pk_fma_f32 v[138:139], v[110:111], v[134:135], v[138:139]
    v_pk_fma_f32 v[140:141], v[112:113], v[134:135], v[140:141]
    v_pk_fma_f32 v[142:143], v[114:115], v[134:135], v[142:143]
    v_pk_fma_f32 v[144:145], v[116:117], v[134:135], v[144:145]
    v_pk_fma_f32 v[146:147], v[118:119], v[134:135], v[146:147]
    v_pk_fma_f32 v[148:149], v[120:121], v[134:135], v[148:149]
    v_pk_fma_f32 v[150:151], v[122:123], v[134:135], v[150:151]
    v_pk_fma_f32 v[152:153], v[124:125], v[134:135], v[152:153]
    v_pk_fma_f32 v[138:139], v[112:113], v[132:133], v[138:139]
    v_pk_fma_f32 v[140:141], v[114:115], v[132:133], v[140:141]
    v_pk_fma_f32 v[142:143], v[116:117], v[132:133], v[142:143]
    v_pk_fma_f32 v[144:145], v[118:119], v[132:133], v[144:145]
    v_pk_fma_f32 v[146:147], v[120:121], v[132:133], v[146:147]
    v_pk_fma_f32 v[148:149], v[122:123], v[132:133], v[148:149]
    v_pk_fma_f32 v[150:151], v[124:125], v[132:133], v[150:151]
    v_pk_fma_f32 v[152:153], v[126:127], v[132:133], v[152:153]
    v_pk_fma_f32 v[138:139], v[114:115], v[130:131], v[138:139]
    v_pk_fma_f32 v[140:141], v[116:117], v[130:131], v[140:141]
    v_pk_fma_f32 v[142:143], v[118:119], v[130:131], v[142:143]
    v_pk_fma_f32 v[144:145], v[120:121], v[130:131], v[144:145]
    v_pk_fma_f32 v[146:147], v[122:123], v[130:131], v[146:147]
    v_pk_fma_f32 v[148:149], v[124:125], v[130:131], v[148:149]
    v_pk_fma_f32 v[150:151], v[126:127], v[130:131], v[150:151]
    v_pk_fma_f32 v[152:153], v[128:129], v[130:131], v[152:153]
    v_lshlrev_b32 v108, 16, v17
    v_and_b32 v109, s65, v17
    v_lshlrev_b32 v110, 16, v21
    v_and_b32 v111, s65, v21
    v_lshlrev_b32 v112, 16, v25
    v_and_b32 v113, s65, v25
    v_lshlrev_b32 v114, 16, v29
    v_and_b32 v115, s65, v29
    v_lshlrev_b32 v116, 16, v33
    v_and_b32 v117, s65, v33
    v_lshlrev_b32 v118, 16, v37
    v_and_b32 v119, s65, v37
    v_lshlrev_b32 v120, 16, v41
    v_and_b32 v121, s65, v41
    v_lshlrev_b32 v122, 16, v45
    v_and_b32 v123, s65, v45
    v_lshlrev_b32 v124, 16, v49
    v_and_b32 v125, s65, v49
    v_lshlrev_b32 v126, 16, v53
    v_and_b32 v127, s65, v53
    v_lshlrev_b32 v128, 16, v57
    v_and_b32 v129, s65, v57
    v_lshlrev_b32 v130, 16, v96
    v_and_b32 v132, s65, v96
    v_lshlrev_b32 v134, 16, v97
    v_and_b32 v136, s65, v97
    v_lshlrev_b32 v131, 16, v98
    v_and_b32 v133, s65, v98
    v_lshlrev_b32 v135, 16, v99
    v_and_b32 v137, s65, v99
    v_pk_mul_f32 v[154:155], v[108:109], v[136:137]
    v_pk_mul_f32 v[156:157], v[110:111], v[136:137]
    v_pk_mul_f32 v[158:159], v[112:113], v[136:137]
    v_pk_mul_f32 v[160:161], v[114:115], v[136:137]
    v_pk_mul_f32 v[162:163], v[116:117], v[136:137]
    v_pk_mul_f32 v[164:165], v[118:119], v[136:137]
    v_pk_mul_f32 v[166:167], v[120:121], v[136:137]
    v_pk_mul_f32 v[168:169], v[122:123], v[136:137]
    v_pk_fma_f32 v[154:155], v[110:111], v[134:135], v[154:155]
    v_pk_fma_f32 v[156:157], v[112:113], v[134:135], v[156:157]
    v_pk_fma_f32 v[158:159], v[114:115], v[134:135], v[158:159]
    v_pk_fma_f32 v[160:161], v[116:117], v[134:135], v[160:161]
    v_pk_fma_f32 v[162:163], v[118:119], v[134:135], v[162:163]
    v_pk_fma_f32 v[164:165], v[120:121], v[134:135], v[164:165]
    v_pk_fma_f32 v[166:167], v[122:123], v[134:135], v[166:167]
    v_pk_fma_f32 v[168:169], v[124:125], v[134:135], v[168:169]
    v_pk_fma_f32 v[154:155], v[112:113], v[132:133], v[154:155]
    v_pk_fma_f32 v[156:157], v[114:115], v[132:133], v[156:157]
    v_pk_fma_f32 v[158:159], v[116:117], v[132:133], v[158:159]
    v_pk_fma_f32 v[160:161], v[118:119], v[132:133], v[160:161]
    v_pk_fma_f32 v[162:163], v[120:121], v[132:133], v[162:163]
    v_pk_fma_f32 v[164:165], v[122:123], v[132:133], v[164:165]
    v_pk_fma_f32 v[166:167], v[124:125], v[132:133], v[166:167]
    v_pk_fma_f32 v[168:169], v[126:127], v[132:133], v[168:169]
    v_pk_fma_f32 v[154:155], v[114:115], v[130:131], v[154:155]
    v_pk_fma_f32 v[156:157], v[116:117], v[130:131], v[156:157]
    v_pk_fma_f32 v[158:159], v[118:119], v[130:131], v[158:159]
    v_pk_fma_f32 v[160:161], v[120:121], v[130:131], v[160:161]
    v_pk_fma_f32 v[162:163], v[122:123], v[130:131], v[162:163]
    v_pk_fma_f32 v[164:165], v[124:125], v[130:131], v[164:165]
    v_pk_fma_f32 v[166:167], v[126:127], v[130:131], v[166:167]
    v_pk_fma_f32 v[168:169], v[128:129], v[130:131], v[168:169]
    v_lshlrev_b32 v108, 16, v18
    v_and_b32 v109, s65, v18
    v_lshlrev_b32 v110, 16, v22
    v_and_b32 v111, s65, v22
    v_lshlrev_b32 v112, 16, v26
    v_and_b32 v113, s65, v26
    v_lshlrev_b32 v114, 16, v30
    v_and_b32 v115, s65, v30
    v_lshlrev_b32 v116, 16, v34
    v_and_b32 v117, s65, v34
    v_lshlrev_b32 v118, 16, v38
    v_and_b32 v119, s65, v38
    v_lshlrev_b32 v120, 16, v42
    v_and_b32 v121, s65, v42
    v_lshlrev_b32 v122, 16, v46
    v_and_b32 v123, s65, v46
    v_lshlrev_b32 v124, 16, v50
    v_and_b32 v125, s65, v50
    v_lshlrev_b32 v126, 16, v54
    v_and_b32 v127, s65, v54
    v_lshlrev_b32 v128, 16, v58
    v_and_b32 v129, s65, v58
    v_lshlrev_b32 v130, 16, v100
    v_and_b32 v132, s65, v100
    v_lshlrev_b32 v134, 16, v101
    v_and_b32 v136, s65, v101
    v_lshlrev_b32 v131, 16, v102
    v_and_b32 v133, s65, v102
    v_lshlrev_b32 v135, 16, v103
    v_and_b32 v137, s65, v103
    v_pk_mul_f32 v[170:171], v[108:109], v[136:137]
    v_pk_mul_f32 v[172:173], v[110:111], v[136:137]
    v_pk_mul_f32 v[174:175], v[112:113], v[136:137]
    v_pk_mul_f32 v[176:177], v[114:115], v[136:137]
    v_pk_mul_f32 v[178:179], v[116:117], v[136:137]
    v_pk_mul_f32 v[180:181], v[118:119], v[136:137]
    v_pk_mul_f32 v[182:183], v[120:121], v[136:137]
    v_pk_mul_f32 v[184:185], v[122:123], v[136:137]
    v_pk_fma_f32 v[170:171], v[110:111], v[134:135], v[170:171]
    v_pk_fma_f32 v[172:173], v[112:113], v[134:135], v[172:173]
    v_pk_fma_f32 v[174:175], v[114:115], v[134:135], v[174:175]
    v_pk_fma_f32 v[176:177], v[116:117], v[134:135], v[176:177]
    v_pk_fma_f32 v[178:179], v[118:119], v[134:135], v[178:179]
    v_pk_fma_f32 v[180:181], v[120:121], v[134:135], v[180:181]
    v_pk_fma_f32 v[182:183], v[122:123], v[134:135], v[182:183]
    v_pk_fma_f32 v[184:185], v[124:125], v[134:135], v[184:185]
    v_pk_fma_f32 v[170:171], v[112:113], v[132:133], v[170:171]
    v_pk_fma_f32 v[172:173], v[114:115], v[132:133], v[172:173]
    v_pk_fma_f32 v[174:175], v[116:117], v[132:133], v[174:175]
    v_pk_fma_f32 v[176:177], v[118:119], v[132:133], v[176:177]
    v_pk_fma_f32 v[178:179], v[120:121], v[132:133], v[178:179]
    v_pk_fma_f32 v[180:181], v[122:123], v[132:133], v[180:181]
    v_pk_fma_f32 v[182:183], v[124:125], v[132:133], v[182:183]
    v_pk_fma_f32 v[184:185], v[126:127], v[132:133], v[184:185]
    v_pk_fma_f32 v[170:171], v[114:115], v[130:131], v[170:171]
    v_pk_fma_f32 v[172:173], v[116:117], v[130:131], v[172:173]
    v_pk_fma_f32 v[174:175], v[118:119], v[130:131], v[174:175]
    v_pk_fma_f32 v[176:177], v[120:121], v[130:131], v[176:177]
    v_pk_fma_f32 v[178:179], v[122:123], v[130:131], v[178:179]
    v_pk_fma_f32 v[180:181], v[124:125], v[130:131], v[180:181]
    v_pk_fma_f32 v[182:183], v[126:127], v[130:131], v[182:183]
    v_pk_fma_f32 v[184:185], v[128:129], v[130:131], v[184:185]
    v_lshlrev_b32 v108, 16, v19
    v_and_b32 v109, s65, v19
    v_lshlrev_b32 v110, 16, v23
    v_and_b32 v111, s65, v23
    v_lshlrev_b32 v112, 16, v27
    v_and_b32 v113, s65, v27
    v_lshlrev_b32 v114, 16, v31
    v_and_b32 v115, s65, v31
    v_lshlrev_b32 v116, 16, v35
    v_and_b32 v117, s65, v35
    v_lshlrev_b32 v118, 16, v39
    v_and_b32 v119, s65, v39
    v_lshlrev_b32 v120, 16, v43
    v_and_b32 v121, s65, v43
    v_lshlrev_b32 v122, 16, v47
    v_and_b32 v123, s65, v47
    v_lshlrev_b32 v124, 16, v51
    v_and_b32 v125, s65, v51
    v_lshlrev_b32 v126, 16, v55
    v_and_b32 v127, s65, v55
    v_lshlrev_b32 v128, 16, v59
    v_and_b32 v129, s65, v59
    v_lshlrev_b32 v130, 16, v104
    v_and_b32 v132, s65, v104
    v_lshlrev_b32 v134, 16, v105
    v_and_b32 v136, s65, v105
    v_lshlrev_b32 v131, 16, v106
    v_and_b32 v133, s65, v106
    v_lshlrev_b32 v135, 16, v107
    v_and_b32 v137, s65, v107
    v_pk_mul_f32 v[186:187], v[108:109], v[136:137]
    v_pk_mul_f32 v[188:189], v[110:111], v[136:137]
    v_pk_mul_f32 v[190:191], v[112:113], v[136:137]
    v_pk_mul_f32 v[192:193], v[114:115], v[136:137]
    v_pk_mul_f32 v[194:195], v[116:117], v[136:137]
    v_pk_mul_f32 v[196:197], v[118:119], v[136:137]
    v_pk_mul_f32 v[198:199], v[120:121], v[136:137]
    v_pk_mul_f32 v[200:201], v[122:123], v[136:137]
    v_pk_fma_f32 v[186:187], v[110:111], v[134:135], v[186:187]
    v_pk_fma_f32 v[188:189], v[112:113], v[134:135], v[188:189]
    v_pk_fma_f32 v[190:191], v[114:115], v[134:135], v[190:191]
    v_pk_fma_f32 v[192:193], v[116:117], v[134:135], v[192:193]
    v_pk_fma_f32 v[194:195], v[118:119], v[134:135], v[194:195]
    v_pk_fma_f32 v[196:197], v[120:121], v[134:135], v[196:197]
    v_pk_fma_f32 v[198:199], v[122:123], v[134:135], v[198:199]
    v_pk_fma_f32 v[200:201], v[124:125], v[134:135], v[200:201]
    v_pk_fma_f32 v[186:187], v[112:113], v[132:133], v[186:187]
    v_pk_fma_f32 v[188:189], v[114:115], v[132:133], v[188:189]
    v_pk_fma_f32 v[190:191], v[116:117], v[132:133], v[190:191]
    v_pk_fma_f32 v[192:193], v[118:119], v[132:133], v[192:193]
    v_pk_fma_f32 v[194:195], v[120:121], v[132:133], v[194:195]
    v_pk_fma_f32 v[196:197], v[122:123], v[132:133], v[196:197]
    v_pk_fma_f32 v[198:199], v[124:125], v[132:133], v[198:199]
    v_pk_fma_f32 v[200:201], v[126:127], v[132:133], v[200:201]
    v_pk_fma_f32 v[186:187], v[114:115], v[130:131], v[186:187]
    v_pk_fma_f32 v[188:189], v[116:117], v[130:131], v[188:189]
    v_pk_fma_f32 v[190:191], v[118:119], v[130:131], v[190:191]
    v_pk_fma_f32 v[192:193], v[120:121], v[130:131], v[192:193]
    v_pk_fma_f32 v[194:195], v[122:123], v[130:131], v[194:195]
    v_pk_fma_f32 v[196:197], v[124:125], v[130:131], v[196:197]
    v_pk_fma_f32 v[198:199], v[126:127], v[130:131], v[198:199]
    v_pk_fma_f32 v[200:201], v[128:129], v[130:131], v[200:201]
    s_mov_b32 s69, 0x4000
K_sp_go:
    s_waitcnt vmcnt(0)
    v_cmp_ne_u32 vcc, 0, v250
    s_cbranch_vccnz K_sp_go2
    s_sleep 4
    buffer_load_dwordx2 v[250:251], v252, s[72:75], s11 offen sc1
    s_sub_u32 s69, s69, 1
    s_cbranch_scc0 K_sp_go
K_sp_go2:
    s_add_u32 s72, s42, 0xc00000
    s_addc_u32 s73, s43, 0
    s_mov_b32 s74, 0x280000
    s_mov_b32 s75, 0x00020000
    v_and_b32 v12, 7, v1
    v_lshrrev_b32 v13, 3, v1
    v_xor_b32 v14, 7, v13
    v_xor_b32 v14, v14, v12
    v_lshlrev_b32 v14, 4, v14
    v_lshl_add_u32 v14, v12, 10, v14
    s_and_b32 s66, s10, 4
    s_add_u32 s66, s66, s10
    s_lshl_b32 s66, s66, 13
    v_add_u32 v14, s66, v14
    v_add_u32 v15, s66, v237
    v_lshlrev_b32 v13, 12, v13
    v_lshlrev_b32 v108, 16, v60
    v_and_b32 v109, s65, v60
    v_lshlrev_b32 v110, 16, v64
    v_and_b32 v111, s65, v64
    v_lshlrev_b32 v112, 16, v68
    v_and_b32 v113, s65, v68
    v_lshlrev_b32 v114, 16, v72
    v_and_b32 v115, s65, v72
    v_lshlrev_b32 v116, 16, v76
    v_and_b32 v117, s65, v76
    v_lshlrev_b32 v118, 16, v80
    v_and_b32 v119, s65, v80
    v_lshlrev_b32 v120, 16, v84
    v_and_b32 v121, s65, v84
    v_lshlrev_b32 v122, 16, v88
    v_and_b32 v123, s65, v88
    v_pk_mul_f32 v[138:139], v[138:139], v[108:109]
    v_pk_mul_f32 v[140:141], v[140:141], v[110:111]
    v_pk_mul_f32 v[142:143], v[142:143], v[112:113]
    v_pk_mul_f32 v[144:145], v[144:145], v[114:115]
    v_pk_mul_f32 v[146:147], v[146:147], v[116:117]
    v_pk_mul_f32 v[148:149], v[148:149], v[118:119]
    v_pk_mul_f32 v[150:151], v[150:151], v[120:121]
    v_pk_mul_f32 v[152:153], v[152:153], v[122:123]
    v_cvt_pk_bf16_f32 v92, v152, v150
    v_cvt_pk_bf16_f32 v93, v148, v146
    v_cvt_pk_bf16_f32 v94, v144, v142
    v_cvt_pk_bf16_f32 v95, v140, v138
    ds_write_b128 v14, v[92:95] offset:0
    v_cvt_pk_bf16_f32 v96, v153, v151
    v_cvt_pk_bf16_f32 v97, v149, v147
    v_cvt_pk_bf16_f32 v98, v145, v143
    v_cvt_pk_bf16_f32 v99, v141, v139
    ds_write_b128 v14, v[96:99] offset:128
    v_lshlrev_b32 v108, 16, v61
    v_and_b32 v109, s65, v61
    v_lshlrev_b32 v110, 16, v65
    v_and_b32 v111, s65, v65
    v_lshlrev_b32 v112, 16, v69
    v_and_b32 v113, s65, v69
    v_lshlrev_b32 v114, 16, v73
    v_and_b32 v115, s65, v73
    v_lshlrev_b32 v116, 16, v77
    v_and_b32 v117, s65, v77
    v_lshlrev_b32 v118, 16, v81
    v_and_b32 v119, s65, v81
    v_lshlrev_b32 v120, 16, v85
    v_and_b32 v121, s65, v85
    v_lshlrev_b32 v122, 16, v89
    v_and_b32 v123, s65, v89
    v_pk_mul_f32 v[154:155], v[154:155], v[108:109]
    v_pk_mul_f32 v[156:157], v[156:157], v[110:111]
    v_pk_mul_f32 v[158:159], v[158:159], v[112:113]
    v_pk_mul_f32 v[160:161], v[160:161], v[114:115]
    v_pk_mul_f32 v[162:163], v[162:163], v[116:117]
    v_pk_mul_f32 v[164:165], v[164:165], v[118:119]
    v_pk_mul_f32 v[166:167], v[166:167], v[120:121]
    v_pk_mul_f32 v[168:169], v[168:169], v[122:123]
    v_cvt_pk_bf16_f32 v100, v168, v166
    v_cvt_pk_bf16_f32 v101, v164, v162
    v_cvt_pk_bf16_f32 v102, v160, v158
    v_cvt_pk_bf16_f32 v103, v156, v154
    ds_write_b128 v14, v[100:103] offset:256
    v_cvt_pk_bf16_f32 v104, v169, v167
    v_cvt_pk_bf16_f32 v105, v165, v163
    v_cvt_pk_bf16_f32 v106, v161, v159
    v_cvt_pk_bf16_f32 v107, v157, v155
    ds_write_b128 v14, v[104:107] offset:384
    v_lshlrev_b32 v108, 16, v62
    v_and_b32 v109, s65, v62
    v_lshlrev_b32 v110, 16, v66
    v_and_b32 v111, s65, v66
    v_lshlrev_b32 v112, 16, v70
    v_and_b32 v113, s65, v70
    v_lshlrev_b32 v114, 16, v74
    v_and_b32 v115, s65, v74
    v_lshlrev_b32 v116, 16, v78
    v_and_b32 v117, s65, v78
    v_lshlrev_b32 v118, 16, v82
    v_and_b32 v119, s65, v82
    v_lshlrev_b32 v120, 16, v86
    v_and_b32 v121, s65, v86
    v_lshlrev_b32 v122, 16, v90
    v_and_b32 v123, s65, v90
    v_pk_mul_f32 v[170:171], v[170:171], v[108:109]
    v_pk_mul_f32 v[172:173], v[172:173], v[110:111]
    v_pk_mul_f32 v[174:175], v[174:175], v[112:113]
    v_pk_mul_f32 v[176:177], v[176:177], v[114:115]
    v_pk_mul_f32 v[178:179], v[178:179], v[116:117]
    v_pk_mul_f32 v[180:181], v[180:181], v[118:119]
    v_pk_mul_f32 v[182:183], v[182:183], v[120:121]
    v_pk_mul_f32 v[184:185], v[184:185], v[122:123]
    v_cvt_pk_bf16_f32 v92, v184, v182
    v_cvt_pk_bf16_f32 v93, v180, v178
    v_cvt_pk_bf16_f32 v94, v176, v174
    v_cvt_pk_bf16_f32 v95, v172, v170
    ds_write_b128 v14, v[92:95] offset:512
    v_cvt_pk_bf16_f32 v96, v185, v183
    v_cvt_pk_bf16_f32 v97, v181, v179
    v_cvt_pk_bf16_f32 v98, v177, v175
    v_cvt_pk_bf16_f32 v99, v173, v171
    ds_write_b128 v14, v[96:99] offset:640
    v_lshlrev_b32 v108, 16, v63
    v_and_b32 v109, s65, v63
    v_lshlrev_b32 v110, 16, v67
    v_and_b32 v111, s65, v67
    v_lshlrev_b32 v112, 16, v71
    v_and_b32 v113, s65, v71
    v_lshlrev_b32 v114, 16, v75
    v_and_b32 v115, s65, v75
    v_lshlrev_b32 v116, 16, v79
    v_and_b32 v117, s65, v79
    v_lshlrev_b32 v118, 16, v83
    v_and_b32 v119, s65, v83
    v_lshlrev_b32 v120, 16, v87
    v_and_b32 v121, s65, v87
    v_lshlrev_b32 v122, 16, v91
    v_and_b32 v123, s65, v91
    v_pk_mul_f32 v[186:187], v[186:187], v[108:109]
    v_pk_mul_f32 v[188:189], v[188:189], v[110:111]
    v_pk_mul_f32 v[190:191], v[190:191], v[112:113]
    v_pk_mul_f32 v[192:193], v[192:193], v[114:115]
    v_pk_mul_f32 v[194:195], v[194:195], v[116:117]
    v_pk_mul_f32 v[196:197], v[196:197], v[118:119]
    v_pk_mul_f32 v[198:199], v[198:199], v[120:121]
    v_pk_mul_f32 v[200:201], v[200:201], v[122:123]
    v_cvt_pk_bf16_f32 v100, v200, v198
    v_cvt_pk_bf16_f32 v101, v196, v194
    v_cvt_pk_bf16_f32 v102, v192, v190
    v_cvt_pk_bf16_f32 v103, v188, v186
    ds_write_b128 v14, v[100:103] offset:768
    v_cvt_pk_bf16_f32 v104, v201, v199
    v_cvt_pk_bf16_f32 v105, v197, v195
    v_cvt_pk_bf16_f32 v106, v193, v191
    v_cvt_pk_bf16_f32 v107, v189, v187
    ds_write_b128 v14, v[104:107] offset:896
    ds_read_b128 v[16:19], v15 offset:0
    ds_read_b128 v[20:23], v15 offset:1024
    ds_read_b128 v[24:27], v15 offset:2048
    ds_read_b128 v[28:31], v15 offset:3072
    ds_read_b128 v[32:35], v15 offset:4096
    ds_read_b128 v[36:39], v15 offset:5120
    ds_read_b128 v[40:43], v15 offset:6144
    ds_read_b128 v[44:47], v15 offset:7168
    v_xor_b32 v108, 0, v12
    v_lshl_add_u32 v108, v108, 4, v13
    v_xor_b32 v109, 1, v12
    v_lshl_add_u32 v109, v109, 4, v13
    v_xor_b32 v110, 2, v12
    v_lshl_add_u32 v110, v110, 4, v13
    v_xor_b32 v111, 3, v12
    v_lshl_add_u32 v111, v111, 4, v13
    v_xor_b32 v112, 4, v12
    v_lshl_add_u32 v112, v112, 4, v13
    v_xor_b32 v113, 5, v12
    v_lshl_add_u32 v113, v113, 4, v13
    v_xor_b32 v114, 6, v12
    v_lshl_add_u32 v114, v114, 4, v13
    v_xor_b32 v115, 7, v12
    v_lshl_add_u32 v115, v115, 4, v13
    s_add_u32 s66, s64, 0
    s_waitcnt lgkmcnt(7)
    buffer_store_dwordx4 v[16:19], v108, s[72:75], s66 offen sc1
    s_add_u32 s66, s64, 32768
    s_waitcnt lgkmcnt(6)
    buffer_store_dwordx4 v[20:23], v109, s[72:75], s66 offen sc1
    s_add_u32 s66, s64, 65536
    s_waitcnt lgkmcnt(5)
    buffer_store_dwordx4 v[24:27], v110, s[72:75], s66 offen sc1
    s_add_u32 s66, s64, 98304
    s_waitcnt lgkmcnt(4)
    buffer_store_dwordx4 v[28:31], v111, s[72:75], s66 offen sc1
    s_add_u32 s66, s64, 131072
    s_waitcnt lgkmcnt(3)
    buffer_store_dwordx4 v[32:35], v112, s[72:75], s66 offen sc1
    s_add_u32 s66, s64, 163840
    s_waitcnt lgkmcnt(2)
    buffer_store_dwordx4 v[36:39], v113, s[72:75], s66 offen sc1
    s_add_u32 s66, s64, 196608
    s_waitcnt lgkmcnt(1)
    buffer_store_dwordx4 v[40:43], v114, s[72:75], s66 offen sc1
    s_add_u32 s66, s64, 229376
    s_waitcnt lgkmcnt(0)
    buffer_store_dwordx4 v[44:47], v115, s[72:75], s66 offen sc1
    v_readfirstlane_b32 s0, v250
    v_readfirstlane_b32 s1, v251
    s_mov_b32 s71, 0
    s_cmp_lt_u32 s10, 4
    s_cbranch_scc1 K_sp_g0
    s_mov_b64 exec, 1
    ds_add_u32 v254, v253 offset:20
    s_mov_b64 exec, -1
    s_lshl_b32 s7, s8, 1
    s_add_u32 s7, s7, 216
    s_mov_b32 s8, 1
    s_mov_b32 s20, 98304
    s_setprio 1
    s_mov_b32 s72, s24
    s_mov_b32 s73, s25
    s_mov_b32 s74, 0x280000
    s_mov_b32 s75, 0x00020000
    s_lshl_b32 s11, s7, 2
    s_load_dword s18, s[26:27], s11
    s_or_b32 s11, s11, 4
    s_load_dword s19, s[26:27], s11
    s_and_b32 s9, s10, 3
    s_xor_b32 s11, s8, 1
    s_lshr_b32 s68, s9, s11
    s_lshl_b32 s66, s7, 1
    s_add_u32 s66, s66, s68
    s_lshl_b32 s66, s66, 12
    s_mul_i32 s67, s68, 13824
    s_add_u32 s67, s67, s20
    v_add_u32 v238, s66, v237
    v_subrev_u32 v239, 2, v238
    v_lshl_add_u32 v246, v1, 7, s66
    s_lshr_b32 s11, s7, 5
    s_lshl_b32 s11, s11, 12
    s_add_u32 s11, s11, 0x40000
    v_min_u32 v248, 31, v1
    v_lshl_add_u32 v248, v248, 7, s11
    s_mov_b32 s68, 0
    buffer_load_dwordx2 v[244:245], v248, s[12:15], 0 offen sc1
    s_add_u32 m0, s67, 512
    s_nop 0
    buffer_load_dwordx4 v238, s[72:75], 0 offen offset:0 lds
    buffer_load_dwordx4 v238, s[72:75], 0 offen offset:1024 lds
    buffer_load_dwordx4 v238, s[72:75], 0 offen offset:2048 lds
    buffer_load_dwordx4 v238, s[72:75], 0 offen offset:3072 lds
    s_add_u32 m0, s67, 5152
    s_nop 0
    buffer_load_dwordx4 v239, s[72:75], 0 offen offset:0 lds
    buffer_load_dwordx4 v239, s[72:75], 0 offen offset:1024 lds
    buffer_load_dwordx4 v239, s[72:75], 0 offen offset:2048 lds
    buffer_load_dwordx4 v239, s[72:75], 0 offen offset:3072 lds
    s_waitcnt vmcnt(9)
    s_mov_b64 exec, 1
    buffer_store_dwordx2 v[250:251], v252, s[12:15], s6 offen sc1
    s_mov_b64 exec, -1
    s_waitcnt vmcnt(9)
    s_mov_b32 s11, 0x4000
POLL_26:
    v_cmp_eq_u64 vcc, s[0:1], v[244:245]
    s_cmp_eq_u64 vcc, -1
    s_cbranch_scc1 POLLD_27
    s_sleep 4
    buffer_load_dwordx2 v[244:245], v248, s[12:15], 0 offen sc1
    s_waitcnt vmcnt(0)
    s_sub_u32 s11, s11, 1
    s_cbranch_scc0 POLL_26
POLLD_27:
    s_add_u32 s48, s42, 0xc00000
    s_addc_u32 s49, s43, 0
    s_mov_b32 s50, 0x280000
    s_mov_b32 s51, 0x00020000
    s_add_u32 m0, s67, 9280
    s_nop 0
    buffer_load_dwordx4 v238, s[48:51], 0 offen offset:0 sc1 lds
    buffer_load_dwordx4 v238, s[48:51], 0 offen offset:1024 sc1 lds
    buffer_load_dwordx4 v238, s[48:51], 0 offen offset:2048 sc1 lds
    buffer_load_dwordx4 v238, s[48:51], 0 offen offset:3072 sc1 lds
    s_mul_i32 s65, s7, 1639
    s_lshr_b32 s65, s65, 16
    s_mul_i32 s6, s65, 40
    s_sub_u32 s6, s7, s6
    s_lshl_b32 s65, s65, 2
    s_add_u32 s65, s65, s9
    s_lshl_b32 s65, s65, 6
    s_add_u32 s6, s6, s65
    s_lshl_b32 s6, s6, 3
    s_add_u32 s6, s6, 0x60000
    s_andn2_b32 s65, s9, s8
    s_and_b32 s65, s65, 1
    s_lshl_b32 s65, s65, 8
    s_add_u32 s65, s65, s67
    v_and_b32 v228, 1, v1
    v_xor_b32 v228, 1, v228
    v_mul_u32_u24 v228, 4640, v228
    v_bfe_u32 v204, v1, 1, 3
    v_lshl_add_u32 v228, v204, 6, v228
    v_lshrrev_b32 v204, 4, v1
    v_lshl_add_u32 v228, v204, 4, v228
    s_add_u32 s69, s65, 64
    v_add_u32 v228, s69, v228
    v_and_b32 v205, 15, v1
    v_lshlrev_b32 v205, 2, v205
    v_lshlrev_b32 v229, 4, v204
    v_sub_u32 v229, v229, v205
    s_add_u32 s69, s65, 9340
    v_add_u32 v229, s69, v229
    v_add_u32 v230, 1024, v229
    v_add_u32 v231, 2048, v229
    v_add_u32 v232, 3072, v229
    v_lshl_add_u32 v205, v204, 7, v205
    s_lshl_b32 s65, s9, 10
    s_sub_u32 s65, 12796, s65
    s_add_u32 s65, s65, s20
    v_sub_u32 v233, s65, v205
    s_mul_i32 s65, s8, 5632
    s_add_u32 s65, s65, 8192
    s_mul_i32 s65, s65, s9
    s_xor_b32 s69, s8, 1
    s_mul_i32 s69, s69, 27648
    s_add_u32 s69, s69, s20
    s_add_u32 s65, s65, s69
    v_add_u32 v234, s65, v237
    s_lshl_b32 s65, s9, 11
    s_add_u32 s69, s69, s65
    v_add_u32 v235, s69, v237
    s_lshl_b32 s66, s7, 13
    s_add_u32 s66, s66, s65
    v_mov_b64 v[108:109], 0
    v_mov_b64 v[110:111], 0
    v_mov_b64 v[112:113], 0
    v_mov_b64 v[114:115], 0
    v_mov_b64 v[116:117], 0
    v_mov_b64 v[118:119], 0
    v_mov_b64 v[120:121], 0
    v_mov_b64 v[122:123], 0
    v_mov_b64 v[124:125], 0
    v_mov_b64 v[126:127], 0
    v_mov_b64 v[128:129], 0
    v_mov_b64 v[130:131], 0
    v_mov_b64 v[132:133], 0
    v_mov_b64 v[134:135], 0
    v_mov_b64 v[136:137], 0
    v_mov_b64 v[138:139], 0
    v_mov_b64 v[206:207], 0
    v_lshl_add_u32 v247, v1, 3, s67
    ds_write_b64 v247, v[206:207] offset:0
    ds_write_b64 v247, v[206:207] offset:4640
    v_lshl_add_u32 v247, v1, 2, s67
    ds_write_b32 v247, v206 offset:13376
    s_waitcnt vmcnt(4)
K_sp_fix:
    v_mov_b32 v247, s67
    ds_read_b128 v[172:175], v247 offset:512
    s_waitcnt lgkmcnt(0)
    v_alignbit_b32 v179, v175, v174, 16
    v_alignbit_b32 v178, v174, v173, 16
    v_alignbit_b32 v177, v173, v172, 16
    v_lshlrev_b32 v176, 16, v172
    ds_write_b128 v247, v[176:179] offset:5152
    ds_read_b128 v[140:143], v228 offset:0
    ds_read_b128 v[144:147], v228 offset:512
    ds_read_b128 v[148:151], v228 offset:1024
    ds_read_b128 v[152:155], v228 offset:1536
    ds_read_b128 v[156:159], v228 offset:2048
    ds_read_b128 v[160:163], v228 offset:2560
    ds_read_b128 v[164:167], v228 offset:3072
    ds_read_b128 v[168:171], v228 offset:3584
    s_waitcnt vmcnt(0)
    s_branch K_conv
K_sp_g0:
    s_mov_b64 exec, 1
    ds_add_u32 v255, v253
    s_mov_b64 exec, -1
    s_add_u32 s71, s71, 4
    s_waitcnt vmcnt(0)
    s_mov_b64 exec, 1
    buffer_store_dwordx2 v[250:251], v252, s[12:15], s6 offen sc1
    s_mov_b64 exec, -1
    s_mov_b32 s6, 0x1000000
    s_add_u32 s7, s8, 296
    s_cmp_ge_u32 s8, 24
    s_cbranch_scc1 K_sp_n
    s_mov_b32 s8, 0
    s_mov_b32 s20, 0
    s_setprio 2
    s_mov_b32 s72, s24
    s_mov_b32 s73, s25
    s_mov_b32 s74, 0x280000
    s_mov_b32 s75, 0x00020000
    s_lshl_b32 s11, s7, 2
    s_load_dword s18, s[26:27], s11
    s_or_b32 s11, s11, 4
    s_load_dword s19, s[26:27], s11
    s_and_b32 s9, s10, 3
    s_xor_b32 s11, s8, 1
    s_lshr_b32 s68, s9, s11
    s_lshl_b32 s66, s7, 1
    s_add_u32 s66, s66, s68
    s_lshl_b32 s66, s66, 12
    s_mul_i32 s67, s68, 13824
    s_add_u32 s67, s67, s20
    v_add_u32 v238, s66, v237
    v_subrev_u32 v239, 2, v238
    v_lshl_add_u32 v246, v1, 7, s66
    s_lshr_b32 s11, s7, 5
    s_lshl_b32 s11, s11, 12
    s_add_u32 s11, s11, 0x40000
    v_min_u32 v248, 31, v1
    v_lshl_add_u32 v248, v248, 7, s11
    s_mov_b32 s68, 0
    s_mov_b32 s11, 0x40000
CS_28:
    ds_read_b32 v247, v255
    s_waitcnt lgkmcnt(0)
    v_cmp_le_u32 vcc, s71, v247
    s_cbranch_vccnz CSD_29
    s_sleep 2
    s_sub_u32 s11, s11, 1
    s_cbranch_scc0 CS_28
CSD_29:
    s_and_b32 s11, s10, 1
    s_lshl_b32 s11, s11, 1
    v_subrev_u32 v239, s11, v238
    s_mul_i32 s11, s11, 2320
    s_add_u32 s11, s11, s67
    s_add_u32 m0, s11, 512
    s_nop 0
    buffer_load_dwordx4 v239, s[72:75], 0 offen offset:0 lds
    buffer_load_dwordx4 v239, s[72:75], 0 offen offset:1024 lds
    buffer_load_dwordx4 v239, s[72:75], 0 offen offset:2048 lds
    buffer_load_dwordx4 v239, s[72:75], 0 offen offset:3072 lds
    s_mul_i32 s65, s7, 1639
    s_lshr_b32 s65, s65, 16
    s_mul_i32 s6, s65, 40
    s_sub_u32 s6, s7, s6
    s_lshl_b32 s65, s65, 2
    s_add_u32 s65, s65, s9
    s_lshl_b32 s65, s65, 6
    s_add_u32 s6, s6, s65
    s_lshl_b32 s6, s6, 3
    s_add_u32 s6, s6, 0x60000
    s_andn2_b32 s65, s9, s8
    s_and_b32 s65, s65, 1
    s_lshl_b32 s65, s65, 8
    s_add_u32 s65, s65, s67
    v_and_b32 v228, 1, v1
    v_xor_b32 v228, 1, v228
    v_mul_u32_u24 v228, 4640, v228
    v_bfe_u32 v204, v1, 1, 3
    v_lshl_add_u32 v228, v204, 6, v228
    v_lshrrev_b32 v204, 4, v1
    v_lshl_add_u32 v228, v204, 4, v228
    s_add_u32 s69, s65, 64
    v_add_u32 v228, s69, v228
    v_and_b32 v205, 15, v1
    v_lshlrev_b32 v205, 2, v205
    v_lshlrev_b32 v229, 4, v204
    v_sub_u32 v229, v229, v205
    s_add_u32 s69, s65, 9340
    v_add_u32 v229, s69, v229
    v_add_u32 v230, 1024, v229
    v_add_u32 v231, 2048, v229
    v_add_u32 v232, 3072, v229
    v_lshl_add_u32 v205, v204, 7, v205
    s_lshl_b32 s65, s9, 10
    s_sub_u32 s65, 12796, s65
    s_add_u32 s65, s65, s20
    v_sub_u32 v233, s65, v205
    s_mul_i32 s65, s8, 5632
    s_add_u32 s65, s65, 8192
    s_mul_i32 s65, s65, s9
    s_xor_b32 s69, s8, 1
    s_mul_i32 s69, s69, 27648
    s_add_u32 s69, s69, s20
    s_add_u32 s65, s65, s69
    v_add_u32 v234, s65, v237
    s_lshl_b32 s65, s9, 11
    s_add_u32 s69, s69, s65
    v_add_u32 v235, s69, v237
    s_lshl_b32 s66, s7, 13
    s_add_u32 s66, s66, s65
    v_mov_b64 v[108:109], 0
    v_mov_b64 v[110:111], 0
    v_mov_b64 v[112:113], 0
    v_mov_b64 v[114:115], 0
    v_mov_b64 v[116:117], 0
    v_mov_b64 v[118:119], 0
    v_mov_b64 v[120:121], 0
    v_mov_b64 v[122:123], 0
    v_mov_b64 v[124:125], 0
    v_mov_b64 v[126:127], 0
    v_mov_b64 v[128:129], 0
    v_mov_b64 v[130:131], 0
    v_mov_b64 v[132:133], 0
    v_mov_b64 v[134:135], 0
    v_mov_b64 v[136:137], 0
    v_mov_b64 v[138:139], 0
    v_mov_b64 v[206:207], 0
    v_lshl_add_u32 v247, v1, 3, s67
    ds_write_b64 v247, v[206:207] offset:0
    ds_write_b64 v247, v[206:207] offset:4640
    v_lshl_add_u32 v247, v1, 2, s67
    ds_write_b32 v247, v206 offset:13376
K_sp_p:
    s_cmp_gt_u32 s10, 1
    s_cbranch_scc1 K_sp_b
    s_cmp_eq_u32 s10, 0
    s_cbranch_scc1 K_sp_a
    s_mov_b32 s11, 0x40000
K_sp_e:
    ds_read_b32 v247, v254 offset:20
    s_waitcnt lgkmcnt(0)
    v_cmp_le_u32 vcc, 4, v247
    s_cbranch_vccnz K_sp_f
    s_sleep 4
    s_sub_u32 s11, s11, 1
    s_cbranch_scc0 K_sp_e
K_sp_f:
    s_and_b32 s11, s4, 7
    s_mul_i32 s11, s11, 5
    s_lshr_b32 s11, s11, 2
    s_mul_i32 s11, s11, 2304
    s_add_u32 s11, s11, 0x50000
    v_min_u32 v248, 35, v1
    v_lshl_add_u32 v248, v248, 7, s11
K_sp_a:
    buffer_load_dwordx2 v[244:245], v248, s[12:15], 0 offen sc1
    s_waitcnt vmcnt(0)
    s_mov_b32 s11, 0x4000
POLL_30:
    v_cmp_eq_u64 vcc, s[0:1], v[244:245]
    s_cmp_eq_u64 vcc, -1
    s_cbranch_scc1 POLLD_31
    s_sleep 4
    buffer_load_dwordx2 v[244:245], v248, s[12:15], 0 offen sc1
    s_waitcnt vmcnt(0)
    s_sub_u32 s11, s11, 1
    s_cbranch_scc0 POLL_30
POLLD_31:
K_sp_b:
    s_waitcnt vmcnt(0) lgkmcnt(0)
    s_mov_b64 exec, 1
    ds_add_u32 v255, v253
    s_mov_b64 exec, -1
    s_add_u32 s71, s71, 4
    s_mov_b32 s11, 0x40000
CS_32:
    ds_read_b32 v247, v255
    s_waitcnt lgkmcnt(0)
    v_cmp_le_u32 vcc, s71, v247
    s_cbranch_vccnz CSD_33
    s_sleep 2
    s_sub_u32 s11, s11, 1
    s_cbranch_scc0 CS_32
CSD_33:
    s_cmp_ge_u32 s7, 320
    s_cbranch_scc1 K_prep_g2b
    s_add_u32 s48, s42, 0xc00000
    s_addc_u32 s49, s43, 0
    s_mov_b32 s50, 0x280000
    s_mov_b32 s51, 0x00020000
    s_add_u32 m0, s67, 9280
    s_nop 0
    buffer_load_dwordx4 v238, s[48:51], 0 offen offset:0 sc1 lds
    buffer_load_dwordx4 v238, s[48:51], 0 offen offset:1024 sc1 lds
    buffer_load_dwordx4 v238, s[48:51], 0 offen offset:2048 sc1 lds
    buffer_load_dwordx4 v238, s[48:51], 0 offen offset:3072 sc1 lds
    s_branch K_sp_fix
K_sp_n:
    s_cmp_eq_u32 s10, 1
    s_cbranch_scc1 K_sp_p
    s_branch K_sp_b
K_prep_g2b:
    s_setprio 0
    s_lshl_b32 s8, s3, 2
    s_lshr_b32 s9, s4, 3
    s_add_u32 s8, s8, s9
    s_and_b32 s9, s4, 7
    s_mul_i32 s67, s9, 5120
    s_add_u32 s67, s67, 0x800000
    s_add_u32 s72, s42, s67
    s_addc_u32 s73, s43, 0
    s_mov_b32 s74, 0x213400
    s_mov_b32 s75, 0x00020000
    s_mov_b32 s65, s10
    s_and_b32 s7, s8, 3
    s_lshl_b32 s7, s7, 2
    s_mul_i32 s69, s10, 5120
    v_add_u32 v238, 4096, v237
    s_mul_i32 s67, s9, 5
    s_lshr_b32 s67, s67, 2
    s_mul_i32 s67, s67, 2304
    s_add_u32 s67, s67, 0x50000
    s_cmp_eq_u32 s10, 0
    s_cselect_b32 s67, s67, 0x1000000
    v_min_u32 v248, 35, v1
    v_lshl_add_u32 v248, v248, 7, s67
    s_xor_b32 s66, s7, 0
    s_add_u32 s66, s66, s65
    s_cmp_ge_u32 s66, 54
    s_cselect_b32 s67, 54, 0
    s_sub_u32 s66, s66, s67
    s_mul_i32 s66, s66, 40960
    buffer_load_dwordx4 v[108:111], v237, s[72:75], s66 offen offset:0 sc1
    buffer_load_dwordx4 v[112:115], v237, s[72:75], s66 offen offset:1024 sc1
    buffer_load_dwordx4 v[116:119], v237, s[72:75], s66 offen offset:2048 sc1
    buffer_load_dwordx4 v[120:123], v237, s[72:75], s66 offen offset:3072 sc1
    buffer_load_dwordx4 v[124:127], v238, s[72:75], s66 offen offset:0 sc1
    s_xor_b32 s66, s7, 4
    s_add_u32 s66, s66, s65
    s_cmp_ge_u32 s66, 54
    s_cselect_b32 s67, 54, 0
    s_sub_u32 s66, s66, s67
    s_mul_i32 s66, s66, 40960
    buffer_load_dwordx4 v[128:131], v237, s[72:75], s66 offen offset:0 sc1
    buffer_load_dwordx4 v[132:135], v237, s[72:75], s66 offen offset:1024 sc1
    buffer_load_dwordx4 v[136:139], v237, s[72:75], s66 offen offset:2048 sc1
    buffer_load_dwordx4 v[140:143], v237, s[72:75], s66 offen offset:3072 sc1
    buffer_load_dwordx4 v[144:147], v238, s[72:75], s66 offen offset:0 sc1
    s_waitcnt vmcnt(10)
    s_mov_b64 exec, 1
    buffer_store_dwordx2 v[250:251], v252, s[12:15], s6 offen sc1
    s_mov_b64 exec, -1
    s_xor_b32 s66, s7, 8
    s_add_u32 s66, s66, s65
    s_cmp_ge_u32 s66, 54
    s_cselect_b32 s67, 54, 0
    s_sub_u32 s66, s66, s67
    s_mul_i32 s66, s66, 40960
    buffer_load_dwordx4 v[148:151], v237, s[72:75], s66 offen offset:0 sc1
    buffer_load_dwordx4 v[152:155], v237, s[72:75], s66 offen offset:1024 sc1
    buffer_load_dwordx4 v[156:159], v237, s[72:75], s66 offen offset:2048 sc1
    buffer_load_dwordx4 v[160:163], v237, s[72:75], s66 offen offset:3072 sc1
    buffer_load_dwordx4 v[164:167], v238, s[72:75], s66 offen offset:0 sc1
    s_xor_b32 s66, s7, 12
    s_add_u32 s66, s66, s65
    s_cmp_ge_u32 s66, 54
    s_cselect_b32 s67, 54, 0
    s_sub_u32 s66, s66, s67
    s_mul_i32 s66, s66, 40960
    buffer_load_dwordx4 v[168:171], v237, s[72:75], s66 offen offset:0 sc1
    buffer_load_dwordx4 v[172:175], v237, s[72:75], s66 offen offset:1024 sc1
    buffer_load_dwordx4 v[176:179], v237, s[72:75], s66 offen offset:2048 sc1
    buffer_load_dwordx4 v[180:183], v237, s[72:75], s66 offen offset:3072 sc1
    buffer_load_dwordx4 v[184:187], v238, s[72:75], s66 offen offset:0 sc1
    s_mov_b32 s11, 0x40000
CS_34:
    ds_read_b32 v247, v255
    s_waitcnt lgkmcnt(0)
    v_cmp_le_u32 vcc, s71, v247
    s_cbranch_vccnz CSD_35
    s_sub_u32 s11, s11, 1
    s_cbranch_scc0 CS_34
CSD_35:
    s_xor_b32 s66, s7, 16
    s_add_u32 s66, s66, s65
    s_cmp_ge_u32 s66, 54
    s_cselect_b32 s67, 54, 0
    s_sub_u32 s66, s66, s67
    s_mul_i32 s66, s66, 40960
    s_add_u32 m0, s69, 49152
    s_nop 0
    buffer_load_dwordx4 v237, s[72:75], s66 offen offset:0 sc1 lds
    buffer_load_dwordx4 v237, s[72:75], s66 offen offset:1024 sc1 lds
    buffer_load_dwordx4 v237, s[72:75], s66 offen offset:2048 sc1 lds
    buffer_load_dwordx4 v237, s[72:75], s66 offen offset:3072 sc1 lds
    s_add_u32 m0, s69, 53248
    s_nop 0
    buffer_load_dwordx4 v238, s[72:75], s66 offen offset:0 sc1 lds
    s_xor_b32 s66, s7, 20
    s_add_u32 s66, s66, s65
    s_cmp_ge_u32 s66, 54
    s_cselect_b32 s67, 54, 0
    s_sub_u32 s66, s66, s67
    s_mul_i32 s66, s66, 40960
    s_add_u32 m0, s69, 69632
    s_nop 0
    buffer_load_dwordx4 v237, s[72:75], s66 offen offset:0 sc1 lds
    buffer_load_dwordx4 v237, s[72:75], s66 offen offset:1024 sc1 lds
    buffer_load_dwordx4 v237, s[72:75], s66 offen offset:2048 sc1 lds
    buffer_load_dwordx4 v237, s[72:75], s66 offen offset:3072 sc1 lds
    s_add_u32 m0, s69, 73728
    s_nop 0
    buffer_load_dwordx4 v238, s[72:75], s66 offen offset:0 sc1 lds
    s_xor_b32 s66, s7, 24
    s_add_u32 s66, s66, s65
    s_cmp_ge_u32 s66, 54
    s_cselect_b32 s67, 54, 0
    s_sub_u32 s66, s66, s67
    s_mul_i32 s66, s66, 40960
    s_add_u32 m0, s69, 0
    s_nop 0
    buffer_load_dwordx4 v237, s[72:75], s66 offen offset:0 sc1 lds
    buffer_load_dwordx4 v237, s[72:75], s66 offen offset:1024 sc1 lds
    buffer_load_dwordx4 v237, s[72:75], s66 offen offset:2048 sc1 lds
    buffer_load_dwordx4 v237, s[72:75], s66 offen offset:3072 sc1 lds
    s_add_u32 m0, s69, 4096
    s_nop 0
    buffer_load_dwordx4 v238, s[72:75], s66 offen offset:0 sc1 lds
    s_xor_b32 s66, s7, 28
    s_add_u32 s66, s66, s65
    s_cmp_ge_u32 s66, 54
    s_cselect_b32 s67, 54, 0
    s_sub_u32 s66, s66, s67
    s_mul_i32 s66, s66, 40960
    s_add_u32 m0, s69, 20480
    s_nop 0
    buffer_load_dwordx4 v237, s[72:75], s66 offen offset:0 sc1 lds
    buffer_load_dwordx4 v237, s[72:75], s66 offen offset:1024 sc1 lds
    buffer_load_dwordx4 v237, s[72:75], s66 offen offset:2048 sc1 lds
    buffer_load_dwordx4 v237, s[72:75], s66 offen offset:3072 sc1 lds
    s_add_u32 m0, s69, 24576
    s_nop 0
    buffer_load_dwordx4 v238, s[72:75], s66 offen offset:0 sc1 lds
K_g2wait:
    s_setprio 0
    v_min_u32 v247, 13, v1
    v_lshlrev_b32 v247, 2, v247
    v_cmp_gt_u32 vcc, 12, v1
    v_xor_b32 v248, s7, v247
    s_nop 0
    v_cndmask_b32 v248, v247, v248, vcc
    v_add_u32 v248, s65, v248
    v_subrev_u32 v247, 54, v248
    v_min_u32 v248, v248, v247
    s_lshl_b32 s67, s8, 13
    v_lshl_add_u32 v248, v248, 7, s67
    v_mov_b32 v22, v248
    v_mov_b32 v2, v237
    v_mov_b32 v3, v238
    s_mul_i32 s67, s8, 221184
    s_add_u32 s56, s42, s67
    s_addc_u32 s57, s43, 0
    s_mov_b32 s58, 0x36000
    s_mov_b32 s59, 0x00020000
    s_xor_b32 s67, s10, 0
    s_lshl_b32 s67, s67, 10
    v_add_u32 v4, s67, v2
    s_xor_b32 s67, s10, 1
    s_lshl_b32 s67, s67, 10
    v_add_u32 v5, s67, v2
    s_xor_b32 s67, s10, 2
    s_lshl_b32 s67, s67, 10
    v_add_u32 v6, s67, v2
    s_xor_b32 s67, s10, 3
    s_lshl_b32 s67, s67, 10
    v_add_u32 v7, s67, v2
    v_add_u32 v24, s69, v2
    v_add_u32 v23, 69632, v24
    s_lshl_b32 s67, s8, 6
    s_lshl_b32 s68, s10, 4
    s_add_u32 s67, s67, s68
    s_mul_i32 s67, s67, 1280
    s_mul_i32 s68, s9, 160
    s_add_u32 s67, s67, s68
    v_add_u32 v10, 0, v1
    v_mul_u32_u24 v12, 205, v10
    v_lshrrev_b32 v12, 11, v12
    v_mul_u32_u24 v12, 1120, v12
    v_lshl_add_u32 v12, v10, 4, v12
    v_add_u32 v12, s67, v12
    v_add_u32 v10, 64, v1
    v_mul_u32_u24 v13, 205, v10
    v_lshrrev_b32 v13, 11, v13
    v_mul_u32_u24 v13, 1120, v13
    v_lshl_add_u32 v13, v10, 4, v13
    v_add_u32 v13, s67, v13
    v_add_u32 v10, 128, v1
    v_mul_u32_u24 v14, 205, v10
    v_lshrrev_b32 v14, 11, v14
    v_mul_u32_u24 v14, 1120, v14
    v_lshl_add_u32 v14, v10, 4, v14
    v_add_u32 v14, s67, v14
    v_lshrrev_b32 v10, 5, v1
    v_lshl_add_u32 v14, v10, 30, v14
    s_lshr_b32 s68, s10, 1
    s_mul_i32 s68, s68, 40960
    s_lshl_b32 s11, s10, 12
    s_add_u32 s68, s68, s11
    s_add_u32 s68, s68, 40960
    v_add_u32 v15, s68, v2
    v_lshrrev_b32 v9, 4, v1
    v_and_b32 v10, 15, v1
    v_mul_u32_u24 v10, 160, v10
    v_lshl_add_u32 v10, v9, 3, v10
    v_add_u32 v10, s68, v10
    s_mov_b32 s48, s38
    s_mov_b32 s49, s39
    s_mov_b32 s50, 0x280000
    s_mov_b32 s51, 0x00020000
    s_mul_i32 s67, s10, 6144
    s_add_u32 s67, s67, 98304
    v_add_u32 v11, s67, v2
    v_lshlrev_b32 v25, 9, v9
    v_bfe_u32 v9, v1, 1, 3
    v_lshl_add_u32 v25, v9, 4, v25
    v_and_b32 v9, 1, v1
    v_lshl_add_u32 v25, v9, 2, v25
    s_and_b32 s67, s10, 1
    s_lshl_b32 s67, s67, 7
    s_lshr_b32 s68, s10, 1
    s_lshl_b32 s68, s68, 3
    s_add_u32 s67, s67, s68
    s_add_u32 s67, s67, 122880
    v_add_u32 v25, s67, v25
    s_mov_b32 s11, 0x4000
K_sp_d:
    buffer_load_dwordx2 v[244:245], v248, s[12:15], 0 offen sc1
    s_waitcnt vmcnt(0)
    v_cmp_eq_u64 s[76:77], s[0:1], v[244:245]
    s_bitcmp1_b32 s76, 0
    s_cbranch_scc1 K_gemm2b
    s_sleep 2
    s_sub_u32 s11, s11, 1
    s_cbranch_scc0 K_sp_d
K_gemm2b:
    s_bitcmp1_b32 s76, 0
    s_cbranch_scc0 FHS_36
    FHB_37:
    s_xor_b32 s70, s7, 0
    s_add_u32 s70, s70, s65
    s_sub_u32 s71, s70, 54
    s_min_u32 s70, s70, s71
    s_lshl_b32 s70, s70, 12
    buffer_load_dwordx4 v[188:191], v4, s[56:59], s70 offen sc1
    buffer_load_dwordx4 v[192:195], v5, s[56:59], s70 offen sc1
    buffer_load_dwordx4 v[196:199], v6, s[56:59], s70 offen sc1
    buffer_load_dwordx4 v[200:203], v7, s[56:59], s70 offen sc1
    s_bitcmp1_b32 s76, 1
    s_cbranch_scc0 FHS_38
    FHB_39:
    s_xor_b32 s70, s7, 4
    s_add_u32 s70, s70, s65
    s_sub_u32 s71, s70, 54
    s_min_u32 s70, s70, s71
    s_lshl_b32 s70, s70, 12
    buffer_load_dwordx4 v[204:207], v4, s[56:59], s70 offen sc1
    buffer_load_dwordx4 v[208:211], v5, s[56:59], s70 offen sc1
    buffer_load_dwordx4 v[212:215], v6, s[56:59], s70 offen sc1
    buffer_load_dwordx4 v[216:219], v7, s[56:59], s70 offen sc1
    s_bitcmp1_b32 s76, 2
    s_cbranch_scc0 FHS_40
    FHB_41:
    s_xor_b32 s70, s7, 8
    s_add_u32 s70, s70, s65
    s_sub_u32 s71, s70, 54
    s_min_u32 s70, s70, s71
    s_lshl_b32 s70, s70, 12
    buffer_load_dwordx4 v[220:223], v4, s[56:59], s70 offen sc1
    buffer_load_dwordx4 v[224:227], v5, s[56:59], s70 offen sc1
    buffer_load_dwordx4 v[228:231], v6, s[56:59], s70 offen sc1
    buffer_load_dwordx4 v[232:235], v7, s[56:59], s70 offen sc1
    s_bitcmp1_b32 s76, 3
    s_cbranch_scc0 FHS_42
    FHB_43:
    s_xor_b32 s70, s7, 12
    s_add_u32 s70, s70, s65
    s_sub_u32 s71, s70, 54
    s_min_u32 s70, s70, s71
    s_lshl_b32 s70, s70, 12
    buffer_load_dwordx4 v[236:239], v4, s[56:59], s70 offen sc1
    buffer_load_dwordx4 v[240:243], v5, s[56:59], s70 offen sc1
    buffer_load_dwordx4 v[244:247], v6, s[56:59], s70 offen sc1
    buffer_load_dwordx4 v[248:251], v7, s[56:59], s70 offen sc1
    s_waitcnt vmcnt(15)
    v_mfma_f32_16x16x32_bf16 v[28:31], v[108:111], v[188:191], 0
    s_bitcmp1_b32 s76, 4
    s_cbranch_scc0 FHS_44
    FHB_45:
    v_mfma_f32_16x16x32_bf16 v[32:35], v[112:115], v[188:191], 0
    s_xor_b32 s70, s7, 16
    s_add_u32 s70, s70, s65
    v_mfma_f32_16x16x32_bf16 v[36:39], v[116:119], v[188:191], 0
    s_sub_u32 s71, s70, 54
    v_mfma_f32_16x16x32_bf16 v[40:43], v[120:123], v[188:191], 0
    s_min_u32 s70, s70, s71
    v_mfma_f32_16x16x32_bf16 v[44:47], v[124:127], v[188:191], 0
    s_lshl_b32 s70, s70, 12
    buffer_load_dwordx4 v[188:191], v4, s[56:59], s70 offen sc1
    s_waitcnt vmcnt(15)
    v_mfma_f32_16x16x32_bf16 v[48:51], v[108:111], v[192:195], 0
    buffer_load_dwordx2 v[26:27], v22, s[12:15], 0 offen sc1
    v_mfma_f32_16x16x32_bf16 v[52:55], v[112:115], v[192:195], 0
    v_mfma_f32_16x16x32_bf16 v[56:59], v[116:119], v[192:195], 0
    v_mfma_f32_16x16x32_bf16 v[60:63], v[120:123], v[192:195], 0
    v_mfma_f32_16x16x32_bf16 v[64:67], v[124:127], v[192:195], 0
    buffer_load_dwordx4 v[192:195], v5, s[56:59], s70 offen sc1
    s_waitcnt vmcnt(16)
    v_mfma_f32_16x16x32_bf16 v[68:71], v[108:111], v[196:199], 0
    v_mfma_f32_16x16x32_bf16 v[72:75], v[112:115], v[196:199], 0
    v_mfma_f32_16x16x32_bf16 v[76:79], v[116:119], v[196:199], 0
    v_mfma_f32_16x16x32_bf16 v[80:83], v[120:123], v[196:199], 0
    v_mfma_f32_16x16x32_bf16 v[84:87], v[124:127], v[196:199], 0
    buffer_load_dwordx4 v[196:199], v6, s[56:59], s70 offen sc1
    s_waitcnt vmcnt(16)
    v_mfma_f32_16x16x32_bf16 v[88:91], v[108:111], v[200:203], 0
    v_mfma_f32_16x16x32_bf16 v[92:95], v[112:115], v[200:203], 0
    v_mfma_f32_16x16x32_bf16 v[96:99], v[116:119], v[200:203], 0
    v_mfma_f32_16x16x32_bf16 v[100:103], v[120:123], v[200:203], 0
    v_mfma_f32_16x16x32_bf16 v[104:107], v[124:127], v[200:203], 0
    buffer_load_dwordx4 v[200:203], v7, s[56:59], s70 offen sc1
    s_waitcnt vmcnt(16)
    v_mfma_f32_16x16x32_bf16 v[28:31], v[128:131], v[204:207], v[28:31]
    s_bitcmp1_b32 s76, 8
    s_cbranch_scc0 FHS_46
    FHB_47:
    v_mfma_f32_16x16x32_bf16 v[32:35], v[132:135], v[204:207], v[32:35]
    s_xor_b32 s70, s7, 32
    s_add_u32 s70, s70, s65
    v_mfma_f32_16x16x32_bf16 v[36:39], v[136:139], v[204:207], v[36:39]
    s_sub_u32 s71, s70, 54
    v_mfma_f32_16x16x32_bf16 v[40:43], v[140:143], v[204:207], v[40:43]
    s_min_u32 s70, s70, s71
    v_mfma_f32_16x16x32_bf16 v[44:47], v[144:147], v[204:207], v[44:47]
    s_lshl_b32 s70, s70, 12
    buffer_load_dwordx4 v[204:207], v4, s[56:59], s70 offen sc1
    s_waitcnt vmcnt(16)
    v_mfma_f32_16x16x32_bf16 v[48:51], v[128:131], v[208:211], v[48:51]
    s_xor_b32 s66, s7, 32
    s_add_u32 s66, s66, s65
    v_mfma_f32_16x16x32_bf16 v[52:55], v[132:135], v[208:211], v[52:55]
    s_sub_u32 s67, s66, 54
    v_mfma_f32_16x16x32_bf16 v[56:59], v[136:139], v[208:211], v[56:59]
    s_min_u32 s66, s66, s67
    v_mfma_f32_16x16x32_bf16 v[60:63], v[140:143], v[208:211], v[60:63]
    s_mul_i32 s66, s66, 40960
    v_mfma_f32_16x16x32_bf16 v[64:67], v[144:147], v[208:211], v[64:67]
    buffer_load_dwordx4 v[208:211], v5, s[56:59], s70 offen sc1
    s_waitcnt vmcnt(16)
    v_mfma_f32_16x16x32_bf16 v[68:71], v[128:131], v[212:215], v[68:71]
    buffer_load_dwordx4 v[108:111], v2, s[72:75], s66 offen offset:0 sc1
    v_mfma_f32_16x16x32_bf16 v[72:75], v[132:135], v[212:215], v[72:75]
    buffer_load_dwordx4 v[112:115], v2, s[72:75], s66 offen offset:1024 sc1
    v_mfma_f32_16x16x32_bf16 v[76:79], v[136:139], v[212:215], v[76:79]
    buffer_load_dwordx4 v[116:119], v2, s[72:75], s66 offen offset:2048 sc1
    v_mfma_f32_16x16x32_bf16 v[80:83], v[140:143], v[212:215], v[80:83]
    buffer_load_dwordx4 v[120:123], v2, s[72:75], s66 offen offset:3072 sc1
    v_mfma_f32_16x16x32_bf16 v[84:87], v[144:147], v[212:215], v[84:87]
    buffer_load_dwordx4 v[212:215], v6, s[56:59], s70 offen sc1
    s_waitcnt vmcnt(20)
    v_mfma_f32_16x16x32_bf16 v[88:91], v[128:131], v[216:219], v[88:91]
    buffer_load_dwordx4 v[124:127], v3, s[72:75], s66 offen offset:0 sc1
    v_mfma_f32_16x16x32_bf16 v[92:95], v[132:135], v[216:219], v[92:95]
    v_mfma_f32_16x16x32_bf16 v[96:99], v[136:139], v[216:219], v[96:99]
    v_mfma_f32_16x16x32_bf16 v[100:103], v[140:143], v[216:219], v[100:103]
    v_mfma_f32_16x16x32_bf16 v[104:107], v[144:147], v[216:219], v[104:107]
    buffer_load_dwordx4 v[216:219], v7, s[56:59], s70 offen sc1
    s_waitcnt vmcnt(21)
    v_mfma_f32_16x16x32_bf16 v[28:31], v[148:151], v[220:223], v[28:31]
    s_bitcmp1_b32 s76, 5
    s_cbranch_scc0 FHS_48
    FHB_49:
    v_mfma_f32_16x16x32_bf16 v[32:35], v[152:155], v[220:223], v[32:35]
    s_xor_b32 s70, s7, 20
    s_add_u32 s70, s70, s65
    v_mfma_f32_16x16x32_bf16 v[36:39], v[156:159], v[220:223], v[36:39]
    s_sub_u32 s71, s70, 54
    v_mfma_f32_16x16x32_bf16 v[40:43], v[160:163], v[220:223], v[40:43]
    s_min_u32 s70, s70, s71
    v_mfma_f32_16x16x32_bf16 v[44:47], v[164:167], v[220:223], v[44:47]
    s_lshl_b32 s70, s70, 12
    buffer_load_dwordx4 v[220:223], v4, s[56:59], s70 offen sc1
    s_waitcnt vmcnt(21)
    v_mfma_f32_16x16x32_bf16 v[48:51], v[148:151], v[224:227], v[48:51]
    s_xor_b32 s66, s7, 36
    s_add_u32 s66, s66, s65
    v_mfma_f32_16x16x32_bf16 v[52:55], v[152:155], v[224:227], v[52:55]
    s_sub_u32 s67, s66, 54
    v_mfma_f32_16x16x32_bf16 v[56:59], v[156:159], v[224:227], v[56:59]
    s_min_u32 s66, s66, s67
    v_mfma_f32_16x16x32_bf16 v[60:63], v[160:163], v[224:227], v[60:63]
    s_mul_i32 s66, s66, 40960
    v_mfma_f32_16x16x32_bf16 v[64:67], v[164:167], v[224:227], v[64:67]
    buffer_load_dwordx4 v[224:227], v5, s[56:59], s70 offen sc1
    s_waitcnt vmcnt(21)
    v_mfma_f32_16x16x32_bf16 v[68:71], v[148:151], v[228:231], v[68:71]
    buffer_load_dwordx4 v[128:131], v2, s[72:75], s66 offen offset:0 sc1
    v_mfma_f32_16x16x32_bf16 v[72:75], v[152:155], v[228:231], v[72:75]
    buffer_load_dwordx4 v[132:135], v2, s[72:75], s66 offen offset:1024 sc1
    v_mfma_f32_16x16x32_bf16 v[76:79], v[156:159], v[228:231], v[76:79]
    buffer_load_dwordx4 v[136:139], v2, s[72:75], s66 offen offset:2048 sc1
    v_mfma_f32_16x16x32_bf16 v[80:83], v[160:163], v[228:231], v[80:83]
    buffer_load_dwordx4 v[140:143], v2, s[72:75], s66 offen offset:3072 sc1
    v_mfma_f32_16x16x32_bf16 v[84:87], v[164:167], v[228:231], v[84:87]
    buffer_load_dwordx4 v[228:231], v6, s[56:59], s70 offen sc1
    s_waitcnt vmcnt(25)
    v_mfma_f32_16x16x32_bf16 v[88:91], v[148:151], v[232:235], v[88:91]
    buffer_load_dwordx4 v[144:147], v3, s[72:75], s66 offen offset:0 sc1
    v_mfma_f32_16x16x32_bf16 v[92:95], v[152:155], v[232:235], v[92:95]
    v_mfma_f32_16x16x32_bf16 v[96:99], v[156:159], v[232:235], v[96:99]
    v_mfma_f32_16x16x32_bf16 v[100:103], v[160:163], v[232:235], v[100:103]
    v_mfma_f32_16x16x32_bf16 v[104:107], v[164:167], v[232:235], v[104:107]
    buffer_load_dwordx4 v[232:235], v7, s[56:59], s70 offen sc1
    s_waitcnt vmcnt(26)
    v_mfma_f32_16x16x32_bf16 v[28:31], v[168:171], v[236:239], v[28:31]
    s_bitcmp1_b32 s76, 9
    s_cbranch_scc0 FHS_50
    FHB_51:
    v_mfma_f32_16x16x32_bf16 v[32:35], v[172:175], v[236:239], v[32:35]
    s_xor_b32 s70, s7, 36
    s_add_u32 s70, s70, s65
    v_mfma_f32_16x16x32_bf16 v[36:39], v[176:179], v[236:239], v[36:39]
    s_sub_u32 s71, s70, 54
    v_mfma_f32_16x16x32_bf16 v[40:43], v[180:183], v[236:239], v[40:43]
    s_min_u32 s70, s70, s71
    v_mfma_f32_16x16x32_bf16 v[44:47], v[184:187], v[236:239], v[44:47]
    s_lshl_b32 s70, s70, 12
    buffer_load_dwordx4 v[236:239], v4, s[56:59], s70 offen sc1
    s_waitcnt vmcnt(26)
    v_mfma_f32_16x16x32_bf16 v[48:51], v[168:171], v[240:243], v[48:51]
    s_waitcnt vmcnt(22)
    v_cmp_eq_u64 s[76:77], s[0:1], v[26:27]
    v_mfma_f32_16x16x32_bf16 v[52:55], v[172:175], v[240:243], v[52:55]
    ds_read_b128 v[148:151], v24 offset:49152
    v_mfma_f32_16x16x32_bf16 v[56:59], v[176:179], v[240:243], v[56:59]
    ds_read_b128 v[152:155], v24 offset:50176
    v_mfma_f32_16x16x32_bf16 v[60:63], v[180:183], v[240:243], v[60:63]
    ds_read_b128 v[156:159], v24 offset:51200
    v_mfma_f32_16x16x32_bf16 v[64:67], v[184:187], v[240:243], v[64:67]
    buffer_load_dwordx4 v[240:243], v5, s[56:59], s70 offen sc1
    v_mfma_f32_16x16x32_bf16 v[68:71], v[168:171], v[244:247], v[68:71]
    ds_read_b128 v[160:163], v24 offset:52224
    v_mfma_f32_16x16x32_bf16 v[72:75], v[172:175], v[244:247], v[72:75]
    ds_read_b128 v[164:167], v24 offset:53248
    v_mfma_f32_16x16x32_bf16 v[76:79], v[176:179], v[244:247], v[76:79]
    buffer_load_dwordx2 v[26:27], v22, s[12:15], 0 offen sc1
    v_mfma_f32_16x16x32_bf16 v[80:83], v[180:183], v[244:247], v[80:83]
    v_mfma_f32_16x16x32_bf16 v[84:87], v[184:187], v[244:247], v[84:87]
    buffer_load_dwordx4 v[244:247], v6, s[56:59], s70 offen sc1
    v_mfma_f32_16x16x32_bf16 v[88:91], v[168:171], v[248:251], v[88:91]
    v_mfma_f32_16x16x32_bf16 v[92:95], v[172:175], v[248:251], v[92:95]
    v_mfma_f32_16x16x32_bf16 v[96:99], v[176:179], v[248:251], v[96:99]
    v_mfma_f32_16x16x32_bf16 v[100:103], v[180:183], v[248:251], v[100:103]
    v_mfma_f32_16x16x32_bf16 v[104:107], v[184:187], v[248:251], v[104:107]
    buffer_load_dwordx4 v[248:251], v7, s[56:59], s70 offen sc1
    s_waitcnt lgkmcnt(0)
    v_mfma_f32_16x16x32_bf16 v[28:31], v[148:151], v[188:191], v[28:31]
    s_bitcmp1_b32 s76, 6
    s_cbranch_scc0 FHS_52
    FHB_53:
    v_mfma_f32_16x16x32_bf16 v[32:35], v[152:155], v[188:191], v[32:35]
    s_xor_b32 s70, s7, 24
    s_add_u32 s70, s70, s65
    v_mfma_f32_16x16x32_bf16 v[36:39], v[156:159], v[188:191], v[36:39]
    s_sub_u32 s71, s70, 54
    v_mfma_f32_16x16x32_bf16 v[40:43], v[160:163], v[188:191], v[40:43]
    s_min_u32 s70, s70, s71
    v_mfma_f32_16x16x32_bf16 v[44:47], v[164:167], v[188:191], v[44:47]
    s_lshl_b32 s70, s70, 12
    buffer_load_dwordx4 v[188:191], v4, s[56:59], s70 offen sc1
    s_waitcnt vmcnt(26)
    v_mfma_f32_16x16x32_bf16 v[48:51], v[148:151], v[192:195], v[48:51]
    s_xor_b32 s66, s7, 40
    s_add_u32 s66, s66, s65
    v_mfma_f32_16x16x32_bf16 v[52:55], v[152:155], v[192:195], v[52:55]
    s_sub_u32 s67, s66, 54
    v_mfma_f32_16x16x32_bf16 v[56:59], v[156:159], v[192:195], v[56:59]
    s_min_u32 s66, s66, s67
    v_mfma_f32_16x16x32_bf16 v[60:63], v[160:163], v[192:195], v[60:63]
    s_mul_i32 s66, s66, 40960
    v_mfma_f32_16x16x32_bf16 v[64:67], v[164:167], v[192:195], v[64:67]
    buffer_load_dwordx4 v[192:195], v5, s[56:59], s70 offen sc1
    s_waitcnt vmcnt(26)
    v_mfma_f32_16x16x32_bf16 v[68:71], v[148:151], v[196:199], v[68:71]
    buffer_load_dwordx4 v[168:171], v2, s[72:75], s66 offen offset:0 sc1
    v_mfma_f32_16x16x32_bf16 v[72:75], v[152:155], v[196:199], v[72:75]
    buffer_load_dwordx4 v[172:175], v2, s[72:75], s66 offen offset:1024 sc1
    v_mfma_f32_16x16x32_bf16 v[76:79], v[156:159], v[196:199], v[76:79]
    buffer_load_dwordx4 v[176:179], v2, s[72:75], s66 offen offset:2048 sc1
    v_mfma_f32_16x16x32_bf16 v[80:83], v[160:163], v[196:199], v[80:83]
    buffer_load_dwordx4 v[180:183], v2, s[72:75], s66 offen offset:3072 sc1
    v_mfma_f32_16x16x32_bf16 v[84:87], v[164:167], v[196:199], v[84:87]
    buffer_load_dwordx4 v[196:199], v6, s[56:59], s70 offen sc1
    s_waitcnt vmcnt(30)
    v_mfma_f32_16x16x32_bf16 v[88:91], v[148:151], v[200:203], v[88:91]
    buffer_load_dwordx4 v[184:187], v3, s[72:75], s66 offen offset:0 sc1
    v_mfma_f32_16x16x32_bf16 v[92:95], v[152:155], v[200:203], v[92:95]
    v_mfma_f32_16x16x32_bf16 v[96:99], v[156:159], v[200:203], v[96:99]
    v_mfma_f32_16x16x32_bf16 v[100:103], v[160:163], v[200:203], v[100:103]
    v_mfma_f32_16x16x32_bf16 v[104:107], v[164:167], v[200:203], v[104:107]
    buffer_load_dwordx4 v[200:203], v7, s[56:59], s70 offen sc1
    s_waitcnt vmcnt(24)
    v_mfma_f32_16x16x32_bf16 v[28:31], v[108:111], v[204:207], v[28:31]
    s_bitcmp1_b32 s76, 10
    s_cbranch_scc0 FHS_54
    FHB_55:
    v_mfma_f32_16x16x32_bf16 v[32:35], v[112:115], v[204:207], v[32:35]
    s_xor_b32 s70, s7, 40
    s_add_u32 s70, s70, s65
    v_mfma_f32_16x16x32_bf16 v[36:39], v[116:119], v[204:207], v[36:39]
    s_sub_u32 s71, s70, 54
    v_mfma_f32_16x16x32_bf16 v[40:43], v[120:123], v[204:207], v[40:43]
    s_min_u32 s70, s70, s71
    v_mfma_f32_16x16x32_bf16 v[44:47], v[124:127], v[204:207], v[44:47]
    s_lshl_b32 s70, s70, 12
    buffer_load_dwordx4 v[204:207], v4, s[56:59], s70 offen sc1
    v_mfma_f32_16x16x32_bf16 v[48:51], v[108:111], v[208:211], v[48:51]
    s_waitcnt vmcnt(12)
    v_cmp_eq_u64 s[76:77], s[0:1], v[26:27]
    v_mfma_f32_16x16x32_bf16 v[52:55], v[112:115], v[208:211], v[52:55]
    ds_read_b128 v[148:151], v23 offset:0
    v_mfma_f32_16x16x32_bf16 v[56:59], v[116:119], v[208:211], v[56:59]
    ds_read_b128 v[152:155], v23 offset:1024
    v_mfma_f32_16x16x32_bf16 v[60:63], v[120:123], v[208:211], v[60:63]
    ds_read_b128 v[156:159], v23 offset:2048
    v_mfma_f32_16x16x32_bf16 v[64:67], v[124:127], v[208:211], v[64:67]
    buffer_load_dwordx4 v[208:211], v5, s[56:59], s70 offen sc1
    v_mfma_f32_16x16x32_bf16 v[68:71], v[108:111], v[212:215], v[68:71]
    ds_read_b128 v[160:163], v23 offset:3072
    v_mfma_f32_16x16x32_bf16 v[72:75], v[112:115], v[212:215], v[72:75]
    ds_read_b128 v[164:167], v23 offset:4096
    v_mfma_f32_16x16x32_bf16 v[76:79], v[116:119], v[212:215], v[76:79]
    ds_write_b32 v254, v253 offset:4
    v_mfma_f32_16x16x32_bf16 v[80:83], v[120:123], v[212:215], v[80:83]
    v_mfma_f32_16x16x32_bf16 v[84:87], v[124:127], v[212:215], v[84:87]
    buffer_load_dwordx4 v[212:215], v6, s[56:59], s70 offen sc1
    v_mfma_f32_16x16x32_bf16 v[88:91], v[108:111], v[216:219], v[88:91]
    v_mfma_f32_16x16x32_bf16 v[92:95], v[112:115], v[216:219], v[92:95]
    v_mfma_f32_16x16x32_bf16 v[96:99], v[116:119], v[216:219], v[96:99]
    v_mfma_f32_16x16x32_bf16 v[100:103], v[120:123], v[216:219], v[100:103]
    v_mfma_f32_16x16x32_bf16 v[104:107], v[124:127], v[216:219], v[104:107]
    buffer_load_dwordx4 v[216:219], v7, s[56:59], s70 offen sc1
    s_waitcnt lgkmcnt(1)
    v_mfma_f32_16x16x32_bf16 v[28:31], v[148:151], v[220:223], v[28:31]
    s_bitcmp1_b32 s76, 7
    s_cbranch_scc0 FHS_56
    FHB_57:
    v_mfma_f32_16x16x32_bf16 v[32:35], v[152:155], v[220:223], v[32:35]
    s_xor_b32 s70, s7, 28
    s_add_u32 s70, s70, s65
    v_mfma_f32_16x16x32_bf16 v[36:39], v[156:159], v[220:223], v[36:39]
    s_sub_u32 s71, s70, 54
    v_mfma_f32_16x16x32_bf16 v[40:43], v[160:163], v[220:223], v[40:43]
    s_min_u32 s70, s70, s71
    v_mfma_f32_16x16x32_bf16 v[44:47], v[164:167], v[220:223], v[44:47]
    s_lshl_b32 s70, s70, 12
    buffer_load_dwordx4 v[220:223], v4, s[56:59], s70 offen sc1
    v_mfma_f32_16x16x32_bf16 v[48:51], v[148:151], v[224:227], v[48:51]
    s_xor_b32 s66, s7, 44
    s_add_u32 s66, s66, s65
    v_mfma_f32_16x16x32_bf16 v[52:55], v[152:155], v[224:227], v[52:55]
    s_sub_u32 s67, s66, 54
    v_mfma_f32_16x16x32_bf16 v[56:59], v[156:159], v[224:227], v[56:59]
    s_min_u32 s66, s66, s67
    v_mfma_f32_16x16x32_bf16 v[60:63], v[160:163], v[224:227], v[60:63]
    s_mul_i32 s66, s66, 40960
    v_mfma_f32_16x16x32_bf16 v[64:67], v[164:167], v[224:227], v[64:67]
    buffer_load_dwordx4 v[224:227], v5, s[56:59], s70 offen sc1
    v_mfma_f32_16x16x32_bf16 v[68:71], v[148:151], v[228:231], v[68:71]
    buffer_load_dwordx4 v[108:111], v2, s[72:75], s66 offen offset:0 sc1
    v_mfma_f32_16x16x32_bf16 v[72:75], v[152:155], v[228:231], v[72:75]
    buffer_load_dwordx4 v[112:115], v2, s[72:75], s66 offen offset:1024 sc1
    v_mfma_f32_16x16x32_bf16 v[76:79], v[156:159], v[228:231], v[76:79]
    buffer_load_dwordx4 v[116:119], v2, s[72:75], s66 offen offset:2048 sc1
    v_mfma_f32_16x16x32_bf16 v[80:83], v[160:163], v[228:231], v[80:83]
    buffer_load_dwordx4 v[120:123], v2, s[72:75], s66 offen offset:3072 sc1
    v_mfma_f32_16x16x32_bf16 v[84:87], v[164:167], v[228:231], v[84:87]
    buffer_load_dwordx4 v[228:231], v6, s[56:59], s70 offen sc1
    v_mfma_f32_16x16x32_bf16 v[88:91], v[148:151], v[232:235], v[88:91]
    buffer_load_dwordx4 v[124:127], v3, s[72:75], s66 offen offset:0 sc1
    v_mfma_f32_16x16x32_bf16 v[92:95], v[152:155], v[232:235], v[92:95]
    v_mfma_f32_16x16x32_bf16 v[96:99], v[156:159], v[232:235], v[96:99]
    v_mfma_f32_16x16x32_bf16 v[100:103], v[160:163], v[232:235], v[100:103]
    v_mfma_f32_16x16x32_bf16 v[104:107], v[164:167], v[232:235], v[104:107]
    buffer_load_dwordx4 v[232:235], v7, s[56:59], s70 offen sc1
    v_mfma_f32_16x16x32_bf16 v[28:31], v[128:131], v[236:239], v[28:31]
    s_bitcmp1_b32 s76, 11
    s_cbranch_scc0 FHS_58
    FHB_59:
    v_mfma_f32_16x16x32_bf16 v[32:35], v[132:135], v[236:239], v[32:35]
    s_xor_b32 s70, s7, 44
    s_add_u32 s70, s70, s65
    v_mfma_f32_16x16x32_bf16 v[36:39], v[136:139], v[236:239], v[36:39]
    s_sub_u32 s71, s70, 54
    v_mfma_f32_16x16x32_bf16 v[40:43], v[140:143], v[236:239], v[40:43]
    s_min_u32 s70, s70, s71
    v_mfma_f32_16x16x32_bf16 v[44:47], v[144:147], v[236:239], v[44:47]
    s_lshl_b32 s70, s70, 12
    buffer_load_dwordx4 v[236:239], v4, s[56:59], s70 offen sc1
    v_mfma_f32_16x16x32_bf16 v[48:51], v[128:131], v[240:243], v[48:51]
    ds_read_b128 v[148:151], v24 offset:0
    v_mfma_f32_16x16x32_bf16 v[52:55], v[132:135], v[240:243], v[52:55]
    ds_read_b128 v[152:155], v24 offset:1024
    v_mfma_f32_16x16x32_bf16 v[56:59], v[136:139], v[240:243], v[56:59]
    ds_read_b128 v[156:159], v24 offset:2048
    v_mfma_f32_16x16x32_bf16 v[60:63], v[140:143], v[240:243], v[60:63]
    ds_read_b128 v[160:163], v24 offset:3072
    v_mfma_f32_16x16x32_bf16 v[64:67], v[144:147], v[240:243], v[64:67]
    buffer_load_dwordx4 v[240:243], v5, s[56:59], s70 offen sc1
    s_waitcnt vmcnt(25)
    v_mfma_f32_16x16x32_bf16 v[68:71], v[128:131], v[244:247], v[68:71]
    ds_read_b128 v[164:167], v24 offset:4096
    v_mfma_f32_16x16x32_bf16 v[72:75], v[132:135], v[244:247], v[72:75]
    v_mfma_f32_16x16x32_bf16 v[76:79], v[136:139], v[244:247], v[76:79]
    v_mfma_f32_16x16x32_bf16 v[80:83], v[140:143], v[244:247], v[80:83]
    v_mfma_f32_16x16x32_bf16 v[84:87], v[144:147], v[244:247], v[84:87]
    buffer_load_dwordx4 v[244:247], v6, s[56:59], s70 offen sc1
    s_waitcnt vmcnt(25)
    v_mfma_f32_16x16x32_bf16 v[88:91], v[128:131], v[248:251], v[88:91]
    v_mfma_f32_16x16x32_bf16 v[92:95], v[132:135], v[248:251], v[92:95]
    v_mfma_f32_16x16x32_bf16 v[96:99], v[136:139], v[248:251], v[96:99]
    v_mfma_f32_16x16x32_bf16 v[100:103], v[140:143], v[248:251], v[100:103]
    v_mfma_f32_16x16x32_bf16 v[104:107], v[144:147], v[248:251], v[104:107]
    buffer_load_dwordx4 v[248:251], v7, s[56:59], s70 offen sc1
    s_waitcnt vmcnt(25) lgkmcnt(0)
    v_mfma_f32_16x16x32_bf16 v[28:31], v[148:151], v[188:191], v[28:31]
    s_bitcmp1_b32 s76, 12
    s_cbranch_scc0 FHS_60
    FHB_61:
    v_mfma_f32_16x16x32_bf16 v[32:35], v[152:155], v[188:191], v[32:35]
    s_add_u32 s70, s65, 48
    v_mfma_f32_16x16x32_bf16 v[36:39], v[156:159], v[188:191], v[36:39]
    s_sub_u32 s71, s70, 54
    v_mfma_f32_16x16x32_bf16 v[40:43], v[160:163], v[188:191], v[40:43]
    s_min_u32 s70, s70, s71
    v_mfma_f32_16x16x32_bf16 v[44:47], v[164:167], v[188:191], v[44:47]
    s_lshl_b32 s70, s70, 12
    buffer_load_dwordx4 v[188:191], v4, s[56:59], s70 offen sc1
    s_waitcnt vmcnt(25)
    v_mfma_f32_16x16x32_bf16 v[48:51], v[148:151], v[192:195], v[48:51]
    s_add_u32 s66, s65, 48
    v_mfma_f32_16x16x32_bf16 v[52:55], v[152:155], v[192:195], v[52:55]
    s_sub_u32 s67, s66, 54
    v_mfma_f32_16x16x32_bf16 v[56:59], v[156:159], v[192:195], v[56:59]
    s_min_u32 s66, s66, s67
    v_mfma_f32_16x16x32_bf16 v[60:63], v[160:163], v[192:195], v[60:63]
    s_mul_i32 s66, s66, 40960
    v_mfma_f32_16x16x32_bf16 v[64:67], v[164:167], v[192:195], v[64:67]
    buffer_load_dwordx4 v[192:195], v5, s[56:59], s70 offen sc1
    s_waitcnt vmcnt(21)
    v_mfma_f32_16x16x32_bf16 v[68:71], v[148:151], v[196:199], v[68:71]
    buffer_load_dwordx4 v[128:131], v2, s[72:75], s66 offen offset:0 sc1
    v_mfma_f32_16x16x32_bf16 v[72:75], v[152:155], v[196:199], v[72:75]
    buffer_load_dwordx4 v[132:135], v2, s[72:75], s66 offen offset:1024 sc1
    v_mfma_f32_16x16x32_bf16 v[76:79], v[156:159], v[196:199], v[76:79]
    buffer_load_dwordx4 v[136:139], v2, s[72:75], s66 offen offset:2048 sc1
    v_mfma_f32_16x16x32_bf16 v[80:83], v[160:163], v[196:199], v[80:83]
    buffer_load_dwordx4 v[140:143], v2, s[72:75], s66 offen offset:3072 sc1
    v_mfma_f32_16x16x32_bf16 v[84:87], v[164:167], v[196:199], v[84:87]
    buffer_load_dwordx4 v[196:199], v6, s[56:59], s70 offen sc1
    s_waitcnt vmcnt(24)
    v_mfma_f32_16x16x32_bf16 v[88:91], v[148:151], v[200:203], v[88:91]
    buffer_load_dwordx4 v[144:147], v3, s[72:75], s66 offen offset:0 sc1
    v_mfma_f32_16x16x32_bf16 v[92:95], v[152:155], v[200:203], v[92:95]
    v_mfma_f32_16x16x32_bf16 v[96:99], v[156:159], v[200:203], v[96:99]
    v_mfma_f32_16x16x32_bf16 v[100:103], v[160:163], v[200:203], v[100:103]
    v_mfma_f32_16x16x32_bf16 v[104:107], v[164:167], v[200:203], v[104:107]
    buffer_load_dwordx4 v[200:203], v7, s[56:59], s70 offen sc1
    s_waitcnt vmcnt(25)
    v_mfma_f32_16x16x32_bf16 v[28:31], v[168:171], v[204:207], v[28:31]
    s_bitcmp1_b32 s76, 13
    s_cbranch_scc0 FHS_62
    FHB_63:
    v_mfma_f32_16x16x32_bf16 v[32:35], v[172:175], v[204:207], v[32:35]
    s_add_u32 s70, s65, 52
    v_mfma_f32_16x16x32_bf16 v[36:39], v[176:179], v[204:207], v[36:39]
    s_sub_u32 s71, s70, 54
    v_mfma_f32_16x16x32_bf16 v[40:43], v[180:183], v[204:207], v[40:43]
    s_min_u32 s70, s70, s71
    v_mfma_f32_16x16x32_bf16 v[44:47], v[184:187], v[204:207], v[44:47]
    s_cmp_ge_u32 s10, 2
    s_cselect_b32 s70, 60, s70
    s_lshl_b32 s70, s70, 12
    buffer_load_dwordx4 v[204:207], v4, s[56:59], s70 offen sc1
    s_waitcnt vmcnt(25)
    v_mfma_f32_16x16x32_bf16 v[48:51], v[168:171], v[208:211], v[48:51]
    ds_read_b128 v[148:151], v24 offset:20480
    v_mfma_f32_16x16x32_bf16 v[52:55], v[172:175], v[208:211], v[52:55]
    ds_read_b128 v[152:155], v24 offset:21504
    v_mfma_f32_16x16x32_bf16 v[56:59], v[176:179], v[208:211], v[56:59]
    ds_read_b128 v[156:159], v24 offset:22528
    v_mfma_f32_16x16x32_bf16 v[60:63], v[180:183], v[208:211], v[60:63]
    ds_read_b128 v[160:163], v24 offset:23552
    v_mfma_f32_16x16x32_bf16 v[64:67], v[184:187], v[208:211], v[64:67]
    buffer_load_dwordx4 v[208:211], v5, s[56:59], s70 offen sc1
    s_waitcnt vmcnt(25)
    v_mfma_f32_16x16x32_bf16 v[68:71], v[168:171], v[212:215], v[68:71]
    ds_read_b128 v[164:167], v24 offset:24576
    v_mfma_f32_16x16x32_bf16 v[72:75], v[172:175], v[212:215], v[72:75]
    v_mfma_f32_16x16x32_bf16 v[76:79], v[176:179], v[212:215], v[76:79]
    v_mfma_f32_16x16x32_bf16 v[80:83], v[180:183], v[212:215], v[80:83]
    v_mfma_f32_16x16x32_bf16 v[84:87], v[184:187], v[212:215], v[84:87]
    buffer_load_dwordx4 v[212:215], v6, s[56:59], s70 offen sc1
    s_waitcnt vmcnt(25)
    v_mfma_f32_16x16x32_bf16 v[88:91], v[168:171], v[216:219], v[88:91]
    v_mfma_f32_16x16x32_bf16 v[92:95], v[172:175], v[216:219], v[92:95]
    v_mfma_f32_16x16x32_bf16 v[96:99], v[176:179], v[216:219], v[96:99]
    v_mfma_f32_16x16x32_bf16 v[100:103], v[180:183], v[216:219], v[100:103]
    v_mfma_f32_16x16x32_bf16 v[104:107], v[184:187], v[216:219], v[104:107]
    buffer_load_dwordx4 v[216:219], v7, s[56:59], s70 offen sc1
    s_waitcnt vmcnt(25) lgkmcnt(0)
    v_mfma_f32_16x16x32_bf16 v[28:31], v[148:151], v[220:223], v[28:31]
    s_add_u32 s66, s65, 52
    v_mfma_f32_16x16x32_bf16 v[32:35], v[152:155], v[220:223], v[32:35]
    s_sub_u32 s67, s66, 54
    v_mfma_f32_16x16x32_bf16 v[36:39], v[156:159], v[220:223], v[36:39]
    s_min_u32 s66, s66, s67
    v_mfma_f32_16x16x32_bf16 v[40:43], v[160:163], v[220:223], v[40:43]
    s_cmp_ge_u32 s10, 2
    s_cselect_b32 s66, 60, s66
    v_mfma_f32_16x16x32_bf16 v[44:47], v[164:167], v[220:223], v[44:47]
    s_mul_i32 s66, s66, 40960
    s_waitcnt vmcnt(24)
    v_mfma_f32_16x16x32_bf16 v[48:51], v[148:151], v[224:227], v[48:51]
    buffer_load_dwordx4 v[168:171], v2, s[72:75], s66 offen offset:0 sc1
    v_mfma_f32_16x16x32_bf16 v[52:55], v[152:155], v[224:227], v[52:55]
    buffer_load_dwordx4 v[172:175], v2, s[72:75], s66 offen offset:1024 sc1
    v_mfma_f32_16x16x32_bf16 v[56:59], v[156:159], v[224:227], v[56:59]
    buffer_load_dwordx4 v[176:179], v2, s[72:75], s66 offen offset:2048 sc1
    v_mfma_f32_16x16x32_bf16 v[60:63], v[160:163], v[224:227], v[60:63]
    buffer_load_dwordx4 v[180:183], v2, s[72:75], s66 offen offset:3072 sc1
    v_mfma_f32_16x16x32_bf16 v[64:67], v[164:167], v[224:227], v[64:67]
    buffer_load_dwordx4 v[184:187], v3, s[72:75], s66 offen offset:0 sc1
    s_waitcnt vmcnt(24)
    v_mfma_f32_16x16x32_bf16 v[68:71], v[148:151], v[228:231], v[68:71]
    v_mfma_f32_16x16x32_bf16 v[72:75], v[152:155], v[228:231], v[72:75]
    v_mfma_f32_16x16x32_bf16 v[76:79], v[156:159], v[228:231], v[76:79]
    v_mfma_f32_16x16x32_bf16 v[80:83], v[160:163], v[228:231], v[80:83]
    v_mfma_f32_16x16x32_bf16 v[84:87], v[164:167], v[228:231], v[84:87]
    s_waitcnt vmcnt(22)
    v_mfma_f32_16x16x32_bf16 v[88:91], v[148:151], v[232:235], v[88:91]
    v_mfma_f32_16x16x32_bf16 v[92:95], v[152:155], v[232:235], v[92:95]
    v_mfma_f32_16x16x32_bf16 v[96:99], v[156:159], v[232:235], v[96:99]
    v_mfma_f32_16x16x32_bf16 v[100:103], v[160:163], v[232:235], v[100:103]
    v_mfma_f32_16x16x32_bf16 v[104:107], v[164:167], v[232:235], v[104:107]
    s_waitcnt vmcnt(21)
    v_mfma_f32_16x16x32_bf16 v[28:31], v[108:111], v[236:239], v[28:31]
    s_xor_b32 s67, s10, 1
    s_mul_i32 s67, s67, 5120
    v_add_u32 v5, s67, v2
    v_mfma_f32_16x16x32_bf16 v[32:35], v[112:115], v[236:239], v[32:35]
    s_xor_b32 s67, s10, 2
    s_mul_i32 s67, s67, 5120
    v_add_u32 v6, s67, v2
    v_mfma_f32_16x16x32_bf16 v[36:39], v[116:119], v[236:239], v[36:39]
    s_xor_b32 s67, s10, 3
    s_mul_i32 s67, s67, 5120
    v_add_u32 v7, s67, v2
    v_mfma_f32_16x16x32_bf16 v[40:43], v[120:123], v[236:239], v[40:43]
    v_mfma_f32_16x16x32_bf16 v[44:47], v[124:127], v[236:239], v[44:47]
    s_waitcnt vmcnt(20)
    v_mfma_f32_16x16x32_bf16 v[48:51], v[108:111], v[240:243], v[48:51]
    v_mfma_f32_16x16x32_bf16 v[52:55], v[112:115], v[240:243], v[52:55]
    v_mfma_f32_16x16x32_bf16 v[56:59], v[116:119], v[240:243], v[56:59]
    v_mfma_f32_16x16x32_bf16 v[60:63], v[120:123], v[240:243], v[60:63]
    v_mfma_f32_16x16x32_bf16 v[64:67], v[124:127], v[240:243], v[64:67]
    s_waitcnt vmcnt(19)
    v_mfma_f32_16x16x32_bf16 v[68:71], v[108:111], v[244:247], v[68:71]
    v_mfma_f32_16x16x32_bf16 v[72:75], v[112:115], v[244:247], v[72:75]
    v_mfma_f32_16x16x32_bf16 v[76:79], v[116:119], v[244:247], v[76:79]
    v_mfma_f32_16x16x32_bf16 v[80:83], v[120:123], v[244:247], v[80:83]
    v_mfma_f32_16x16x32_bf16 v[84:87], v[124:127], v[244:247], v[84:87]
    s_waitcnt vmcnt(18)
    v_mfma_f32_16x16x32_bf16 v[88:91], v[108:111], v[248:251], v[88:91]
    v_mfma_f32_16x16x32_bf16 v[92:95], v[112:115], v[248:251], v[92:95]
    v_mfma_f32_16x16x32_bf16 v[96:99], v[116:119], v[248:251], v[96:99]
    v_mfma_f32_16x16x32_bf16 v[100:103], v[120:123], v[248:251], v[100:103]
    v_mfma_f32_16x16x32_bf16 v[104:107], v[124:127], v[248:251], v[104:107]
    s_waitcnt vmcnt(10)
    v_mfma_f32_16x16x32_bf16 v[28:31], v[128:131], v[188:191], v[28:31]
    v_mfma_f32_16x16x32_bf16 v[32:35], v[132:135], v[188:191], v[32:35]
    v_mfma_f32_16x16x32_bf16 v[36:39], v[136:139], v[188:191], v[36:39]
    v_mfma_f32_16x16x32_bf16 v[40:43], v[140:143], v[188:191], v[40:43]
    v_mfma_f32_16x16x32_bf16 v[44:47], v[144:147], v[188:191], v[44:47]
    v_mfma_f32_16x16x32_bf16 v[48:51], v[128:131], v[192:195], v[48:51]
    v_mfma_f32_16x16x32_bf16 v[52:55], v[132:135], v[192:195], v[52:55]
    v_mfma_f32_16x16x32_bf16 v[56:59], v[136:139], v[192:195], v[56:59]
    v_mfma_f32_16x16x32_bf16 v[60:63], v[140:143], v[192:195], v[60:63]
    v_mfma_f32_16x16x32_bf16 v[64:67], v[144:147], v[192:195], v[64:67]
    v_mfma_f32_16x16x32_bf16 v[68:71], v[128:131], v[196:199], v[68:71]
    v_mfma_f32_16x16x32_bf16 v[72:75], v[132:135], v[196:199], v[72:75]
    v_mfma_f32_16x16x32_bf16 v[76:79], v[136:139], v[196:199], v[76:79]
    v_mfma_f32_16x16x32_bf16 v[80:83], v[140:143], v[196:199], v[80:83]
    v_mfma_f32_16x16x32_bf16 v[84:87], v[144:147], v[196:199], v[84:87]
    s_waitcnt vmcnt(9)
    v_mfma_f32_16x16x32_bf16 v[88:91], v[128:131], v[200:203], v[88:91]
    v_mfma_f32_16x16x32_bf16 v[92:95], v[132:135], v[200:203], v[92:95]
    v_mfma_f32_16x16x32_bf16 v[96:99], v[136:139], v[200:203], v[96:99]
    v_mfma_f32_16x16x32_bf16 v[100:103], v[140:143], v[200:203], v[100:103]
    v_mfma_f32_16x16x32_bf16 v[104:107], v[144:147], v[200:203], v[104:107]
    s_waitcnt vmcnt(0)
    v_mfma_f32_16x16x32_bf16 v[48:51], v[168:171], v[208:211], v[48:51]
    v_mfma_f32_16x16x32_bf16 v[52:55], v[172:175], v[208:211], v[52:55]
    v_mfma_f32_16x16x32_bf16 v[56:59], v[176:179], v[208:211], v[56:59]
    v_mfma_f32_16x16x32_bf16 v[60:63], v[180:183], v[208:211], v[60:63]
    v_mfma_f32_16x16x32_bf16 v[64:67], v[184:187], v[208:211], v[64:67]
    v_mfma_f32_16x16x32_bf16 v[68:71], v[168:171], v[212:215], v[68:71]
    v_mfma_f32_16x16x32_bf16 v[72:75], v[172:175], v[212:215], v[72:75]
    v_mfma_f32_16x16x32_bf16 v[76:79], v[176:179], v[212:215], v[76:79]
    v_mfma_f32_16x16x32_bf16 v[80:83], v[180:183], v[212:215], v[80:83]
    v_mfma_f32_16x16x32_bf16 v[84:87], v[184:187], v[212:215], v[84:87]
    ds_write_b128 v24, v[48:51] offset:0
    v_mfma_f32_16x16x32_bf16 v[88:91], v[168:171], v[216:219], v[88:91]
    ds_write_b128 v24, v[52:55] offset:1024
    v_mfma_f32_16x16x32_bf16 v[92:95], v[172:175], v[216:219], v[92:95]
    ds_write_b128 v24, v[56:59] offset:2048
    v_mfma_f32_16x16x32_bf16 v[96:99], v[176:179], v[216:219], v[96:99]
    ds_write_b128 v24, v[60:63] offset:3072
    v_mfma_f32_16x16x32_bf16 v[100:103], v[180:183], v[216:219], v[100:103]
    ds_write_b128 v24, v[64:67] offset:4096
    v_mfma_f32_16x16x32_bf16 v[104:107], v[184:187], v[216:219], v[104:107]
    ds_write_b128 v24, v[68:71] offset:20480
    v_mfma_f32_16x16x32_bf16 v[28:31], v[168:171], v[204:207], v[28:31]
    ds_write_b128 v24, v[72:75] offset:21504
    v_mfma_f32_16x16x32_bf16 v[32:35], v[172:175], v[204:207], v[32:35]
    ds_write_b128 v24, v[76:79] offset:22528
    v_mfma_f32_16x16x32_bf16 v[36:39], v[176:179], v[204:207], v[36:39]
    ds_write_b128 v24, v[80:83] offset:23552
    v_mfma_f32_16x16x32_bf16 v[40:43], v[180:183], v[204:207], v[40:43]
    ds_write_b128 v24, v[84:87] offset:24576
    v_mfma_f32_16x16x32_bf16 v[44:47], v[184:187], v[204:207], v[44:47]
    ds_write_b128 v24, v[88:91] offset:49152
    ds_write_b128 v24, v[92:95] offset:50176
    ds_write_b128 v24, v[96:99] offset:51200
    ds_write_b128 v24, v[100:103] offset:52224
    ds_write_b128 v24, v[104:107] offset:53248
    s_waitcnt lgkmcnt(0)
    s_barrier
    ds_read_b64 v[8:9], v11 offset:5120
    s_mov_b32 s67, 0xffff0000
    ds_read2st64_b32 v[148:149], v25 offset0:0 offset1:1
    ds_read_b128 v[108:111], v11 offset:0
    ds_read_b128 v[48:51], v5 offset:0
    ds_read_b128 v[68:71], v6 offset:20480
    ds_read_b128 v[88:91], v7 offset:49152
    ds_read2st64_b32 v[150:151], v25 offset0:8 offset1:9
    ds_read_b128 v[112:115], v11 offset:1024
    ds_read_b128 v[52:55], v5 offset:1024
    ds_read_b128 v[72:75], v6 offset:21504
    ds_read_b128 v[92:95], v7 offset:50176
    ds_read2st64_b32 v[152:153], v25 offset0:16 offset1:17
    ds_read_b128 v[116:119], v11 offset:2048
    ds_read_b128 v[56:59], v5 offset:2048
    ds_read_b128 v[76:79], v6 offset:22528
    ds_read_b128 v[96:99], v7 offset:51200
    s_waitcnt lgkmcnt(13)
    v_lshlrev_b32 v188, 16, v148
    v_and_b32 v189, s67, v148
    v_lshlrev_b32 v190, 16, v149
    v_and_b32 v191, s67, v149
    v_pk_mul_f32 v[108:109], v[108:109], v[188:189]
    v_pk_mul_f32 v[110:111], v[110:111], v[190:191]
    s_waitcnt lgkmcnt(10)
    v_pk_add_f32 v[28:29], v[28:29], v[48:49]
    v_pk_add_f32 v[68:69], v[68:69], v[88:89]
    v_pk_add_f32 v[30:31], v[30:31], v[50:51]
    v_pk_add_f32 v[70:71], v[70:71], v[90:91]
    v_pk_add_f32 v[28:29], v[28:29], v[68:69]
    v_pk_add_f32 v[30:31], v[30:31], v[70:71]
    v_pk_fma_f32 v[28:29], v[28:29], v[8:9], v[108:109]
    v_pk_fma_f32 v[30:31], v[30:31], v[8:9], v[110:111]
    v_cvt_pk_bf16_f32 v128, v28, v29
    v_cvt_pk_bf16_f32 v129, v30, v31
    ds_read2st64_b32 v[154:155], v25 offset0:24 offset1:25
    ds_read_b128 v[120:123], v11 offset:3072
    ds_read_b128 v[60:63], v5 offset:3072
    ds_read_b128 v[80:83], v6 offset:23552
    ds_read_b128 v[100:103], v7 offset:52224
    s_waitcnt lgkmcnt(13)
    v_lshlrev_b32 v188, 16, v150
    v_and_b32 v189, s67, v150
    v_lshlrev_b32 v190, 16, v151
    v_and_b32 v191, s67, v151
    v_pk_mul_f32 v[112:113], v[112:113], v[188:189]
    v_pk_mul_f32 v[114:115], v[114:115], v[190:191]
    s_waitcnt lgkmcnt(10)
    v_pk_add_f32 v[32:33], v[32:33], v[52:53]
    v_pk_add_f32 v[72:73], v[72:73], v[92:93]
    v_pk_add_f32 v[34:35], v[34:35], v[54:55]
    v_pk_add_f32 v[74:75], v[74:75], v[94:95]
    v_pk_add_f32 v[32:33], v[32:33], v[72:73]
    v_pk_add_f32 v[34:35], v[34:35], v[74:75]
    v_pk_fma_f32 v[32:33], v[32:33], v[8:9], v[112:113]
    v_pk_fma_f32 v[34:35], v[34:35], v[8:9], v[114:115]
    v_cvt_pk_bf16_f32 v130, v32, v33
    v_cvt_pk_bf16_f32 v131, v34, v35
    ds_read2st64_b32 v[156:157], v25 offset0:32 offset1:33
    ds_read_b128 v[124:127], v11 offset:4096
    ds_read_b128 v[64:67], v5 offset:4096
    ds_read_b128 v[84:87], v6 offset:24576
    ds_read_b128 v[104:107], v7 offset:53248
    s_waitcnt lgkmcnt(13)
    v_lshlrev_b32 v188, 16, v152
    v_and_b32 v189, s67, v152
    v_lshlrev_b32 v190, 16, v153
    v_and_b32 v191, s67, v153
    v_pk_mul_f32 v[116:117], v[116:117], v[188:189]
    v_pk_mul_f32 v[118:119], v[118:119], v[190:191]
    s_waitcnt lgkmcnt(10)
    v_pk_add_f32 v[36:37], v[36:37], v[56:57]
    v_pk_add_f32 v[76:77], v[76:77], v[96:97]
    v_pk_add_f32 v[38:39], v[38:39], v[58:59]
    v_pk_add_f32 v[78:79], v[78:79], v[98:99]
    v_pk_add_f32 v[36:37], v[36:37], v[76:77]
    v_pk_add_f32 v[38:39], v[38:39], v[78:79]
    v_pk_fma_f32 v[36:37], v[36:37], v[8:9], v[116:117]
    v_pk_fma_f32 v[38:39], v[38:39], v[8:9], v[118:119]
    v_cvt_pk_bf16_f32 v132, v36, v37
    v_cvt_pk_bf16_f32 v133, v38, v39
    s_waitcnt lgkmcnt(8)
    v_lshlrev_b32 v188, 16, v154
    v_and_b32 v189, s67, v154
    v_lshlrev_b32 v190, 16, v155
    v_and_b32 v191, s67, v155
    v_pk_mul_f32 v[120:121], v[120:121], v[188:189]
    v_pk_mul_f32 v[122:123], v[122:123], v[190:191]
    s_waitcnt lgkmcnt(5)
    v_pk_add_f32 v[40:41], v[40:41], v[60:61]
    v_pk_add_f32 v[80:81], v[80:81], v[100:101]
    v_pk_add_f32 v[42:43], v[42:43], v[62:63]
    v_pk_add_f32 v[82:83], v[82:83], v[102:103]
    v_pk_add_f32 v[40:41], v[40:41], v[80:81]
    v_pk_add_f32 v[42:43], v[42:43], v[82:83]
    v_pk_fma_f32 v[40:41], v[40:41], v[8:9], v[120:121]
    v_pk_fma_f32 v[42:43], v[42:43], v[8:9], v[122:123]
    v_cvt_pk_bf16_f32 v134, v40, v41
    v_cvt_pk_bf16_f32 v135, v42, v43
    s_waitcnt lgkmcnt(3)
    v_lshlrev_b32 v188, 16, v156
    v_and_b32 v189, s67, v156
    v_lshlrev_b32 v190, 16, v157
    v_and_b32 v191, s67, v157
    v_pk_mul_f32 v[124:125], v[124:125], v[188:189]
    v_pk_mul_f32 v[126:127], v[126:127], v[190:191]
    s_waitcnt lgkmcnt(0)
    v_pk_add_f32 v[44:45], v[44:45], v[64:65]
    v_pk_add_f32 v[84:85], v[84:85], v[104:105]
    v_pk_add_f32 v[46:47], v[46:47], v[66:67]
    v_pk_add_f32 v[86:87], v[86:87], v[106:107]
    v_pk_add_f32 v[44:45], v[44:45], v[84:85]
    v_pk_add_f32 v[46:47], v[46:47], v[86:87]
    v_pk_fma_f32 v[44:45], v[44:45], v[8:9], v[124:125]
    v_pk_fma_f32 v[46:47], v[46:47], v[8:9], v[126:127]
    v_cvt_pk_bf16_f32 v136, v44, v45
    v_cvt_pk_bf16_f32 v137, v46, v47
    ds_write_b64 v10, v[128:129] offset:0
    ds_write_b64 v10, v[130:131] offset:32
    ds_write_b64 v10, v[132:133] offset:64
    ds_write_b64 v10, v[134:135] offset:96
    ds_write_b64 v10, v[136:137] offset:128
    ds_read_b128 v[16:19], v15 offset:0
    ds_read_b128 v[20:23], v15 offset:1024
    ds_read_b128 v[24:27], v15 offset:2048
    s_waitcnt lgkmcnt(2)
    buffer_store_dwordx4 v[16:19], v12, s[48:51], 0 offen
    s_waitcnt lgkmcnt(1)
    buffer_store_dwordx4 v[20:23], v13, s[48:51], 0 offen
    s_waitcnt lgkmcnt(0)
    buffer_store_dwordx4 v[24:27], v14, s[48:51], 0 offen
    s_endpgm
FHS_36:
    s_mov_b32 s11, 0x4000
SL_64:
    buffer_load_dwordx2 v[26:27], v22, s[12:15], 0 offen sc1
    s_waitcnt vmcnt(0)
    v_cmp_eq_u64 s[76:77], s[0:1], v[26:27]
    s_bitcmp1_b32 s76, 0
    s_cbranch_scc1 FHB_37
    s_sleep 2
    s_sub_u32 s11, s11, 1
    s_cbranch_scc0 SL_64
    s_branch FHB_37
FHS_38:
    s_mov_b32 s11, 0x4000
SL_65:
    buffer_load_dwordx2 v[26:27], v22, s[12:15], 0 offen sc1
    s_waitcnt vmcnt(0)
    v_cmp_eq_u64 s[76:77], s[0:1], v[26:27]
    s_bitcmp1_b32 s76, 1
    s_cbranch_scc1 FHB_39
    s_sleep 2
    s_sub_u32 s11, s11, 1
    s_cbranch_scc0 SL_65
    s_branch FHB_39
FHS_40:
    s_mov_b32 s11, 0x4000
SL_66:
    buffer_load_dwordx2 v[26:27], v22, s[12:15], 0 offen sc1
    s_waitcnt vmcnt(0)
    v_cmp_eq_u64 s[76:77], s[0:1], v[26:27]
    s_bitcmp1_b32 s76, 2
    s_cbranch_scc1 FHB_41
    s_sleep 2
    s_sub_u32 s11, s11, 1
    s_cbranch_scc0 SL_66
    s_branch FHB_41
FHS_42:
    s_mov_b32 s11, 0x4000
SL_67:
    buffer_load_dwordx2 v[26:27], v22, s[12:15], 0 offen sc1
    s_waitcnt vmcnt(0)
    v_cmp_eq_u64 s[76:77], s[0:1], v[26:27]
    s_bitcmp1_b32 s76, 3
    s_cbranch_scc1 FHB_43
    s_sleep 2
    s_sub_u32 s11, s11, 1
    s_cbranch_scc0 SL_67
    s_branch FHB_43
FHS_44:
    s_mov_b32 s11, 0x4000
SL_68:
    buffer_load_dwordx2 v[26:27], v22, s[12:15], 0 offen sc1
    s_waitcnt vmcnt(0)
    v_cmp_eq_u64 s[76:77], s[0:1], v[26:27]
    s_bitcmp1_b32 s76, 4
    s_cbranch_scc1 FHB_45
    s_sleep 2
    s_sub_u32 s11, s11, 1
    s_cbranch_scc0 SL_68
    s_branch FHB_45
FHS_46:
    s_mov_b32 s11, 0x4000
SL_69:
    buffer_load_dwordx2 v[26:27], v22, s[12:15], 0 offen sc1
    s_waitcnt vmcnt(0)
    v_cmp_eq_u64 s[76:77], s[0:1], v[26:27]
    s_bitcmp1_b32 s76, 8
    s_cbranch_scc1 FHB_47
    s_sleep 2
    s_sub_u32 s11, s11, 1
    s_cbranch_scc0 SL_69
    s_branch FHB_47
FHS_48:
    s_mov_b32 s11, 0x4000
SL_70:
    buffer_load_dwordx2 v[26:27], v22, s[12:15], 0 offen sc1
    s_waitcnt vmcnt(0)
    v_cmp_eq_u64 s[76:77], s[0:1], v[26:27]
    s_bitcmp1_b32 s76, 5
    s_cbranch_scc1 FHB_49
    s_sleep 2
    s_sub_u32 s11, s11, 1
    s_cbranch_scc0 SL_70
    s_branch FHB_49
FHS_50:
    s_mov_b32 s11, 0x4000
SL_71:
    buffer_load_dwordx2 v[26:27], v22, s[12:15], 0 offen sc1
    s_waitcnt vmcnt(0)
    v_cmp_eq_u64 s[76:77], s[0:1], v[26:27]
    s_bitcmp1_b32 s76, 9
    s_cbranch_scc1 FHB_51
    s_sleep 2
    s_sub_u32 s11, s11, 1
    s_cbranch_scc0 SL_71
    s_branch FHB_51
FHS_52:
    s_mov_b32 s11, 0x4000
SL_72:
    buffer_load_dwordx2 v[26:27], v22, s[12:15], 0 offen sc1
    s_waitcnt vmcnt(0)
    v_cmp_eq_u64 s[76:77], s[0:1], v[26:27]
    s_bitcmp1_b32 s76, 6
    s_cbranch_scc1 FHB_53
    s_sleep 2
    s_sub_u32 s11, s11, 1
    s_cbranch_scc0 SL_72
    s_branch FHB_53
FHS_54:
    s_mov_b32 s11, 0x4000
SL_73:
    buffer_load_dwordx2 v[26:27], v22, s[12:15], 0 offen sc1
    s_waitcnt vmcnt(0)
    v_cmp_eq_u64 s[76:77], s[0:1], v[26:27]
    s_bitcmp1_b32 s76, 10
    s_cbranch_scc1 FHB_55
    s_sleep 2
    s_sub_u32 s11, s11, 1
    s_cbranch_scc0 SL_73
    s_branch FHB_55
FHS_56:
    s_mov_b32 s11, 0x4000
SL_74:
    buffer_load_dwordx2 v[26:27], v22, s[12:15], 0 offen sc1
    s_waitcnt vmcnt(0)
    v_cmp_eq_u64 s[76:77], s[0:1], v[26:27]
    s_bitcmp1_b32 s76, 7
    s_cbranch_scc1 FHB_57
    s_sleep 2
    s_sub_u32 s11, s11, 1
    s_cbranch_scc0 SL_74
    s_branch FHB_57
FHS_58:
    s_mov_b32 s11, 0x4000
SL_75:
    buffer_load_dwordx2 v[26:27], v22, s[12:15], 0 offen sc1
    s_waitcnt vmcnt(0)
    v_cmp_eq_u64 s[76:77], s[0:1], v[26:27]
    s_bitcmp1_b32 s76, 11
    s_cbranch_scc1 FHB_59
    s_sleep 2
    s_sub_u32 s11, s11, 1
    s_cbranch_scc0 SL_75
    s_branch FHB_59
FHS_60:
    s_mov_b32 s11, 0x4000
SL_76:
    buffer_load_dwordx2 v[26:27], v22, s[12:15], 0 offen sc1
    s_waitcnt vmcnt(0)
    v_cmp_eq_u64 s[76:77], s[0:1], v[26:27]
    s_bitcmp1_b32 s76, 12
    s_cbranch_scc1 FHB_61
    s_sleep 2
    s_sub_u32 s11, s11, 1
    s_cbranch_scc0 SL_76
    s_branch FHB_61
FHS_62:
    s_mov_b32 s11, 0x4000
SL_77:
    buffer_load_dwordx2 v[26:27], v22, s[12:15], 0 offen sc1
    s_waitcnt vmcnt(0)
    v_cmp_eq_u64 s[76:77], s[0:1], v[26:27]
    s_bitcmp1_b32 s76, 13
    s_cbranch_scc1 FHB_63
    s_sleep 2
    s_sub_u32 s11, s11, 1
    s_cbranch_scc0 SL_77
    s_branch FHB_63
K_exit:
    s_endpgm
CODE_END:
.section .rodata,"a"
.p2align 6
.amdhsa_kernel gated_mix__ssm_conv_h3__glu_gated_swiglu__prompt_kernel
  .amdhsa_next_free_vgpr 256
  .amdhsa_next_free_sgpr 102
  .amdhsa_accum_offset 256
  .amdhsa_group_segment_fixed_size 0
  .amdhsa_kernarg_size 112
  .amdhsa_user_sgpr_count 2
  .amdhsa_user_sgpr_kernarg_segment_ptr 1
  .amdhsa_system_sgpr_workgroup_id_x 1
.end_amdhsa_kernel
```
